```python
import torch

def _softmax(x, axis=-1):
    return torch.softmax(x, dim=axis)
def _gelu(x):
    return torch.nn.functional.gelu(x, approximate="tanh")
def _silu(x):
    return torch.nn.functional.silu(x)
def _sigmoid(x):
    return torch.sigmoid(x)
def _layernorm(x, axis=-1, eps=1e-5):
    m = x.mean(dim=axis, keepdim=True)
    v = x.var(dim=axis, keepdim=True, unbiased=False)
    return (x - m) / torch.sqrt(v + eps)
def _scatter_add(tgt, idx, src, axis=0):
    return tgt.clone().index_add_(axis, idx, src)
def _segment_sum(src, seg, n):
    out = torch.zeros((n,) + src.shape[1:], dtype=src.dtype)
    return out.index_add_(0, seg, src)
def _pad(x, pw):
    flat = tuple(v for pair in reversed(pw) for v in pair)
    return torch.nn.functional.pad(x, flat)

kernel_name = 'sequential_preLN__sliding_block_cached__dense_activation_gelu__decode'

def setup_inputs():

    _w = (lambda a: (lambda t: t.to(torch.bfloat16) if t.is_floating_point() else t)(torch.as_tensor(a)))
    def _A_setup():
        B, Sq, D = 1, 1, 512
        Hq, Hkv, Sk, Dh = 32, 8, 65536, 128
        assert Hq % Hkv == 0, (Hq, Hkv)
        return {
            "x": _w((lambda *s: torch.randn(*s, dtype=torch.bfloat16) * 0.1)(B, Sq, D)),
            "k_cache": _w((lambda *s: torch.randn(*s, dtype=torch.bfloat16) * 1.6)(B, Hkv, Sk, Dh)),
            "v_cache": _w((lambda *s: torch.randn(*s, dtype=torch.bfloat16) * 1.6)(B, Hkv, Sk, Dh)),
            "wq": _w((lambda *s: torch.randn(*s, dtype=torch.bfloat16) * 1.6)(D, Hq * Dh) * (D ** -0.5)),
            "wo": _w((lambda *s: torch.randn(*s, dtype=torch.bfloat16) * 1.6)(Hq * Dh, D) * ((Hq * Dh) ** -0.5)),
        }
    _A_in = _A_setup()

    def _B_setup():
        B, S, D, F = 1, 1, 512, 1792
        return {
            "x": _w((lambda *s: torch.randn(*s, dtype=torch.bfloat16) * 0.1)(B, S, D)),
            "w1": _w((lambda *s: torch.randn(*s, dtype=torch.bfloat16) * 3.2)(D, F) * (D ** -0.5)),
            "b1": _w((lambda *s: torch.randn(*s, dtype=torch.bfloat16) * 3.2)(F) * 0.01),
            "w2": _w((lambda *s: torch.randn(*s, dtype=torch.bfloat16) * 3.2)(F, D) * (F ** -0.5)),
            "b2": _w((lambda *s: torch.randn(*s, dtype=torch.bfloat16) * 3.2)(D) * 0.01),
        }
    _B_in = _B_setup()

    return {
        "A_x": _A_in["x"],
        "A_k_cache": _A_in["k_cache"],
        "A_v_cache": _A_in["v_cache"],
        "A_wq": _A_in["wq"],
        "A_wo": _A_in["wo"],
        "B_x": _B_in["x"],
        "B_w1": _B_in["w1"],
        "B_b1": _B_in["b1"],
        "B_w2": _B_in["w2"],
        "B_b2": _B_in["b2"],
    }

def reference(A_x, A_k_cache, A_v_cache, A_wq, A_wo, B_x, B_w1, B_b1, B_w2, B_b2):
    def _A_ref(x, k_cache, v_cache, wq, wo):
        B, Sq, D = x.shape
        Hq, Dh = 32, 128
        Hkv, Sk = k_cache.shape[1], k_cache.shape[2]
        W = min(4096, max(256, Sk // 4))
        rep = Hq // Hkv
        q = (lambda x, *d: x.permute(*d))((x @ wq).reshape(B, Sq, Hq, Dh), 0, 2, 1, 3)
        k = (lambda x, n, axis: torch.repeat_interleave(x, n, dim=axis))(k_cache[:, :, Sk - W:, :], rep, axis=1)
        v = (lambda x, n, axis: torch.repeat_interleave(x, n, dim=axis))(v_cache[:, :, Sk - W:, :], rep, axis=1)
        scores = torch.einsum("bhqd,bhkd->bhqk", q, k) * (Dh ** -0.5)
        p = _softmax(scores, axis=-1)
        o = torch.einsum("bhqk,bhkd->bhqd", p, v)
        return (lambda x, *d: x.permute(*d))(o, 0, 2, 1, 3).reshape(B, Sq, Hq * Dh) @ wo

    def _B_ref(x, w1, b1, w2, b2):
        h = torch.einsum("bsd,df->bsf", x, w1) + b1
        h = _gelu(h)
        return torch.einsum("bsf,fd->bsd", h, w2) + b2

    x = A_x
    h = x + _A_ref(_layernorm(x, axis=-1), A_k_cache, A_v_cache, A_wq, A_wo)
    h2 = h + _B_ref(_layernorm(h, axis=-1), B_w1, B_b1, B_w2, B_b2)
    return h2
```

```asm
; @launch grid=(256,1,1) block=(320,1,1) lds=41472
.amdgcn_target "amdgcn-amd-amdhsa--gfx950"
.text
.globl sequential_preLN__sliding_block_cached__dense_activation_gelu__decode_kernel
.p2align 8
.type sequential_preLN__sliding_block_cached__dense_activation_gelu__decode_kernel,@function
sequential_preLN__sliding_block_cached__dense_activation_gelu__decode_kernel:
    s_cmp_ge_u32 s2, 256
    s_cbranch_scc1 END
    s_load_dwordx16 s[64:79], s[0:1], 0
    s_load_dwordx8 s[80:87], s[0:1], 64
    s_load_dwordx2 s[88:89], s[0:1], 96
    v_and_b32 v1, 63, v0
    v_and_b32 v2, 15, v1
    v_lshrrev_b32 v3, 4, v1
    v_lshrrev_b32 v4, 6, v0
    v_lshrrev_b32 v5, 3, v0
    v_and_b32 v6, 7, v0
    v_and_b32 v7, 3, v1
    v_readfirstlane_b32 s60, v4
    s_lshr_b32 s61, s2, 5
    s_and_b32 s62, s2, 31
    s_waitcnt lgkmcnt(0)
    s_mov_b32 s12, s64
    s_and_b32 s13, s65, 0xffff
    s_mov_b32 s14, 1024
    s_mov_b32 s15, 0x00020000
    s_mov_b32 s16, s66
    s_and_b32 s17, s67, 0xffff
    s_mov_b32 s18, 134217728
    s_mov_b32 s19, 0x00020000
    s_mov_b32 s20, s68
    s_and_b32 s21, s69, 0xffff
    s_mov_b32 s22, 134217728
    s_mov_b32 s23, 0x00020000
    s_mov_b32 s24, s70
    s_and_b32 s25, s71, 0xffff
    s_mov_b32 s26, 4194304
    s_mov_b32 s27, 0x00020000
    s_mov_b32 s28, s72
    s_and_b32 s29, s73, 0xffff
    s_mov_b32 s30, 4194304
    s_mov_b32 s31, 0x00020000
    s_mov_b32 s32, s76
    s_and_b32 s33, s77, 0xffff
    s_mov_b32 s34, 1835008
    s_mov_b32 s35, 0x00020000
    s_mov_b32 s36, s80
    s_and_b32 s37, s81, 0xffff
    s_mov_b32 s38, 1835008
    s_mov_b32 s39, 0x00020000
    s_mov_b32 s40, s88
    s_and_b32 s41, s89, 0xffff
    s_mov_b32 s42, 4194304
    s_mov_b32 s43, 0x00020000
    s_mov_b32 s44, s86
    s_and_b32 s45, s87, 0xffff
    s_mov_b32 s46, 256
    s_mov_b32 s47, 0x00020000
    s_mov_b32 s48, s78
    s_and_b32 s49, s79, 0xffff
    s_mov_b32 s50, 3584
    s_mov_b32 s51, 0x00020000
    s_mov_b32 s52, s82
    s_and_b32 s53, s83, 0xffff
    s_mov_b32 s54, 1024
    s_mov_b32 s55, 0x00020000
    s_mov_b32 s56, s84
    s_and_b32 s57, s85, 0xffff
    s_mov_b32 s58, 1024
    s_mov_b32 s59, 0x00020000
    s_cmp_eq_u32 s60, 4
    s_cbranch_scc1 MW
    v_lshlrev_b32 v144, 4, v1
    buffer_load_dwordx4 v[156:159], v144, s[12:15], 0 offen
    v_lshlrev_b32 v145, 13, v5
    v_lshl_add_u32 v145, v6, 4, v145
    s_and_b32 s63, s2, 3
    s_lshl_b32 s63, s63, 20
    s_lshr_b32 s64, s2, 2
    s_lshl_b32 s64, s64, 7
    s_add_u32 s63, s63, s64
    s_add_u32 s64, s63, 0
    buffer_load_dwordx4 v[8:11], v145, s[24:27], s64 offen
    s_add_u32 s64, s63, 262144
    buffer_load_dwordx4 v[12:15], v145, s[24:27], s64 offen
    s_add_u32 s64, s63, 524288
    buffer_load_dwordx4 v[16:19], v145, s[24:27], s64 offen
    s_add_u32 s64, s63, 786432
    buffer_load_dwordx4 v[20:23], v145, s[24:27], s64 offen
    s_barrier
    s_lshl_b32 s98, s61, 24
    s_lshl_b32 s65, s62, 15
    s_add_u32 s98, s98, s65
    s_add_u32 s98, s98, 15728640
    v_lshlrev_b32 v136, 5, v4
    v_add_u32 v136, v136, v2
    v_lshlrev_b32 v136, 8, v136
    v_lshl_add_u32 v136, v3, 4, v136
    v_add_u32 v137, 4096, v136
    v_lshlrev_b32 v138, 5, v4
    v_lshl_add_u32 v138, v3, 2, v138
    v_lshlrev_b32 v138, 8, v138
    v_lshl_add_u32 v138, v2, 4, v138
    v_add_u32 v139, 4096, v138
    s_waitcnt vmcnt(4)
    v_lshlrev_b32 v160, 16, v156
    v_and_b32 v161, 0xffff0000, v156
    v_lshlrev_b32 v162, 16, v157
    v_and_b32 v163, 0xffff0000, v157
    v_lshlrev_b32 v164, 16, v158
    v_and_b32 v165, 0xffff0000, v158
    v_lshlrev_b32 v166, 16, v159
    v_and_b32 v167, 0xffff0000, v159
    v_add_f32 v170, v160, v161
    v_add_f32 v170, v170, v162
    v_add_f32 v170, v170, v163
    v_add_f32 v170, v170, v164
    v_add_f32 v170, v170, v165
    v_add_f32 v170, v170, v166
    v_add_f32 v170, v170, v167
    s_nop 1
    v_add_f32_dpp v170, v170, v170 quad_perm:[1,0,3,2] row_mask:0xf bank_mask:0xf
    s_nop 1
    v_add_f32_dpp v170, v170, v170 quad_perm:[2,3,0,1] row_mask:0xf bank_mask:0xf
    s_nop 1
    v_add_f32_dpp v170, v170, v170 row_half_mirror row_mask:0xf bank_mask:0xf
    s_nop 1
    v_add_f32_dpp v170, v170, v170 row_mirror row_mask:0xf bank_mask:0xf
    s_nop 1
    v_readlane_b32 s90, v170, 0
    v_readlane_b32 s91, v170, 16
    v_readlane_b32 s92, v170, 32
    v_readlane_b32 s93, v170, 48
    s_nop 1
    v_mov_b32 v170, s90
    v_add_f32 v170, s91, v170
    v_add_f32 v170, s92, v170
    v_add_f32 v170, s93, v170
    v_mul_f32 v170, 989855744, v170
    v_mov_b32 v171, 0
    v_sub_f32 v172, v160, v170
    v_fmac_f32 v171, v172, v172
    v_sub_f32 v172, v161, v170
    v_fmac_f32 v171, v172, v172
    v_sub_f32 v172, v162, v170
    v_fmac_f32 v171, v172, v172
    v_sub_f32 v172, v163, v170
    v_fmac_f32 v171, v172, v172
    v_sub_f32 v172, v164, v170
    v_fmac_f32 v171, v172, v172
    v_sub_f32 v172, v165, v170
    v_fmac_f32 v171, v172, v172
    v_sub_f32 v172, v166, v170
    v_fmac_f32 v171, v172, v172
    v_sub_f32 v172, v167, v170
    v_fmac_f32 v171, v172, v172
    s_nop 1
    v_add_f32_dpp v171, v171, v171 quad_perm:[1,0,3,2] row_mask:0xf bank_mask:0xf
    s_nop 1
    v_add_f32_dpp v171, v171, v171 quad_perm:[2,3,0,1] row_mask:0xf bank_mask:0xf
    s_nop 1
    v_add_f32_dpp v171, v171, v171 row_half_mirror row_mask:0xf bank_mask:0xf
    s_nop 1
    v_add_f32_dpp v171, v171, v171 row_mirror row_mask:0xf bank_mask:0xf
    s_nop 1
    v_readlane_b32 s90, v171, 0
    v_readlane_b32 s91, v171, 16
    v_readlane_b32 s92, v171, 32
    v_readlane_b32 s93, v171, 48
    s_nop 1
    v_mov_b32 v171, s90
    v_add_f32 v171, s91, v171
    v_add_f32 v171, s92, v171
    v_add_f32 v171, s93, v171
    v_mul_f32 v171, 989855744, v171
    v_cvt_pk_bf16_f32 v170, v170, v170
    v_lshlrev_b32 v170, 16, v170
    v_cvt_pk_bf16_f32 v171, v171, v171
    v_lshlrev_b32 v171, 16, v171
    v_add_f32 v171, 925353388, v171
    v_cvt_pk_bf16_f32 v171, v171, v171
    v_lshlrev_b32 v171, 16, v171
    v_sqrt_f32 v171, v171
    s_nop 0
    v_cvt_pk_bf16_f32 v171, v171, v171
    v_lshlrev_b32 v171, 16, v171
    v_rcp_f32 v172, v171
    s_nop 0
    v_sub_f32 v173, v160, v170
    v_cvt_pk_bf16_f32 v173, v173, v173
    v_lshlrev_b32 v173, 16, v173
    v_mul_f32 v160, v173, v172
    v_fma_f32 v174, -v160, v171, v173
    v_fma_f32 v160, v174, v172, v160
    v_cvt_pk_bf16_f32 v160, v160, v160
    v_lshlrev_b32 v160, 16, v160
    v_sub_f32 v173, v161, v170
    v_cvt_pk_bf16_f32 v173, v173, v173
    v_lshlrev_b32 v173, 16, v173
    v_mul_f32 v161, v173, v172
    v_fma_f32 v174, -v161, v171, v173
    v_fma_f32 v161, v174, v172, v161
    v_cvt_pk_bf16_f32 v161, v161, v161
    v_lshlrev_b32 v161, 16, v161
    v_sub_f32 v173, v162, v170
    v_cvt_pk_bf16_f32 v173, v173, v173
    v_lshlrev_b32 v173, 16, v173
    v_mul_f32 v162, v173, v172
    v_fma_f32 v174, -v162, v171, v173
    v_fma_f32 v162, v174, v172, v162
    v_cvt_pk_bf16_f32 v162, v162, v162
    v_lshlrev_b32 v162, 16, v162
    v_sub_f32 v173, v163, v170
    v_cvt_pk_bf16_f32 v173, v173, v173
    v_lshlrev_b32 v173, 16, v173
    v_mul_f32 v163, v173, v172
    v_fma_f32 v174, -v163, v171, v173
    v_fma_f32 v163, v174, v172, v163
    v_cvt_pk_bf16_f32 v163, v163, v163
    v_lshlrev_b32 v163, 16, v163
    v_sub_f32 v173, v164, v170
    v_cvt_pk_bf16_f32 v173, v173, v173
    v_lshlrev_b32 v173, 16, v173
    v_mul_f32 v164, v173, v172
    v_fma_f32 v174, -v164, v171, v173
    v_fma_f32 v164, v174, v172, v164
    v_cvt_pk_bf16_f32 v164, v164, v164
    v_lshlrev_b32 v164, 16, v164
    v_sub_f32 v173, v165, v170
    v_cvt_pk_bf16_f32 v173, v173, v173
    v_lshlrev_b32 v173, 16, v173
    v_mul_f32 v165, v173, v172
    v_fma_f32 v174, -v165, v171, v173
    v_fma_f32 v165, v174, v172, v165
    v_cvt_pk_bf16_f32 v165, v165, v165
    v_lshlrev_b32 v165, 16, v165
    v_sub_f32 v173, v166, v170
    v_cvt_pk_bf16_f32 v173, v173, v173
    v_lshlrev_b32 v173, 16, v173
    v_mul_f32 v166, v173, v172
    v_fma_f32 v174, -v166, v171, v173
    v_fma_f32 v166, v174, v172, v166
    v_cvt_pk_bf16_f32 v166, v166, v166
    v_lshlrev_b32 v166, 16, v166
    v_sub_f32 v173, v167, v170
    v_cvt_pk_bf16_f32 v173, v173, v173
    v_lshlrev_b32 v173, 16, v173
    v_mul_f32 v167, v173, v172
    v_fma_f32 v174, -v167, v171, v173
    v_fma_f32 v167, v174, v172, v167
    v_cvt_pk_bf16_f32 v167, v167, v167
    v_lshlrev_b32 v167, 16, v167
    v_lshlrev_b32 v144, 5, v1
    ds_write_b128 v144, v[160:163] offset:0
    ds_write_b128 v144, v[164:167] offset:16
    s_waitcnt lgkmcnt(0)
    s_and_b32 s69, s2, 3
    s_lshl_b32 s69, s69, 7
    v_add_u32 v144, s69, v5
    v_lshlrev_b32 v144, 2, v144
    ds_read_b32 v176, v144 offset:0
    ds_read_b32 v178, v144 offset:128
    ds_read_b32 v180, v144 offset:256
    ds_read_b32 v182, v144 offset:384
    v_mov_b32 v160, 0
    v_mov_b32 v161, 0
    v_mov_b32 v162, 0
    v_mov_b32 v163, 0
    v_mov_b32 v164, 0
    v_mov_b32 v165, 0
    v_mov_b32 v166, 0
    v_mov_b32 v167, 0
    s_waitcnt vmcnt(0) lgkmcnt(0)
    buffer_load_dwordx4 v[24:27], v136, s[16:19], s98 offen offset:0
    buffer_load_dwordx4 v[28:31], v136, s[16:19], s98 offen offset:64
    buffer_load_dwordx4 v[32:35], v136, s[16:19], s98 offen offset:128
    buffer_load_dwordx4 v[36:39], v136, s[16:19], s98 offen offset:192
    v_lshlrev_b32 v168, 16, v8
    v_and_b32 v169, 0xffff0000, v8
    v_lshlrev_b32 v170, 16, v9
    v_and_b32 v171, 0xffff0000, v9
    v_lshlrev_b32 v172, 16, v10
    v_and_b32 v173, 0xffff0000, v10
    v_lshlrev_b32 v174, 16, v11
    v_and_b32 v175, 0xffff0000, v11
    v_pk_fma_f32 v[160:161], v[176:177], v[168:169], v[160:161] op_sel_hi:[0,1,1]
    v_pk_fma_f32 v[162:163], v[176:177], v[170:171], v[162:163] op_sel_hi:[0,1,1]
    v_pk_fma_f32 v[164:165], v[176:177], v[172:173], v[164:165] op_sel_hi:[0,1,1]
    v_pk_fma_f32 v[166:167], v[176:177], v[174:175], v[166:167] op_sel_hi:[0,1,1]
    v_lshlrev_b32 v168, 16, v12
    v_and_b32 v169, 0xffff0000, v12
    v_lshlrev_b32 v170, 16, v13
    v_and_b32 v171, 0xffff0000, v13
    v_lshlrev_b32 v172, 16, v14
    v_and_b32 v173, 0xffff0000, v14
    v_lshlrev_b32 v174, 16, v15
    v_and_b32 v175, 0xffff0000, v15
    v_pk_fma_f32 v[160:161], v[178:179], v[168:169], v[160:161] op_sel_hi:[0,1,1]
    v_pk_fma_f32 v[162:163], v[178:179], v[170:171], v[162:163] op_sel_hi:[0,1,1]
    v_pk_fma_f32 v[164:165], v[178:179], v[172:173], v[164:165] op_sel_hi:[0,1,1]
    v_pk_fma_f32 v[166:167], v[178:179], v[174:175], v[166:167] op_sel_hi:[0,1,1]
    v_lshlrev_b32 v168, 16, v16
    v_and_b32 v169, 0xffff0000, v16
    v_lshlrev_b32 v170, 16, v17
    v_and_b32 v171, 0xffff0000, v17
    v_lshlrev_b32 v172, 16, v18
    v_and_b32 v173, 0xffff0000, v18
    v_lshlrev_b32 v174, 16, v19
    v_and_b32 v175, 0xffff0000, v19
    v_pk_fma_f32 v[160:161], v[180:181], v[168:169], v[160:161] op_sel_hi:[0,1,1]
    v_pk_fma_f32 v[162:163], v[180:181], v[170:171], v[162:163] op_sel_hi:[0,1,1]
    v_pk_fma_f32 v[164:165], v[180:181], v[172:173], v[164:165] op_sel_hi:[0,1,1]
    v_pk_fma_f32 v[166:167], v[180:181], v[174:175], v[166:167] op_sel_hi:[0,1,1]
    v_lshlrev_b32 v168, 16, v20
    v_and_b32 v169, 0xffff0000, v20
    v_lshlrev_b32 v170, 16, v21
    v_and_b32 v171, 0xffff0000, v21
    v_lshlrev_b32 v172, 16, v22
    v_and_b32 v173, 0xffff0000, v22
    v_lshlrev_b32 v174, 16, v23
    v_and_b32 v175, 0xffff0000, v23
    v_pk_fma_f32 v[160:161], v[182:183], v[168:169], v[160:161] op_sel_hi:[0,1,1]
    v_pk_fma_f32 v[162:163], v[182:183], v[170:171], v[162:163] op_sel_hi:[0,1,1]
    v_pk_fma_f32 v[164:165], v[182:183], v[172:173], v[164:165] op_sel_hi:[0,1,1]
    v_pk_fma_f32 v[166:167], v[182:183], v[174:175], v[166:167] op_sel_hi:[0,1,1]
    v_lshlrev_b32 v144, 8, v5
    v_lshl_add_u32 v144, v6, 5, v144
    ds_write_b128 v144, v[160:163] offset:8192
    ds_write_b128 v144, v[164:167] offset:8208
    v_mov_b32 v144, 3076
    v_mov_b32 v145, 1
    s_waitcnt lgkmcnt(0)
    ds_add_u32 v144, v145
    s_waitcnt vmcnt(3)
    buffer_load_dwordx4 v[40:43], v137, s[16:19], s98 offen offset:0
    s_waitcnt vmcnt(3)
    buffer_load_dwordx4 v[44:47], v137, s[16:19], s98 offen offset:64
    s_waitcnt vmcnt(3)
    buffer_load_dwordx4 v[48:51], v137, s[16:19], s98 offen offset:128
    s_waitcnt vmcnt(3)
    buffer_load_dwordx4 v[52:55], v137, s[16:19], s98 offen offset:192
    s_waitcnt vmcnt(3)
    buffer_load_dwordx4 v[56:59], v138, s[20:23], s98 offen offset:0
    s_waitcnt vmcnt(3)
    buffer_load_dwordx4 v[60:63], v138, s[20:23], s98 offen offset:256
    s_waitcnt vmcnt(3)
    buffer_load_dwordx4 v[64:67], v138, s[20:23], s98 offen offset:512
    s_waitcnt vmcnt(3)
    buffer_load_dwordx4 v[68:71], v138, s[20:23], s98 offen offset:768
    buffer_load_dwordx4 v[72:75], v139, s[20:23], s98 offen offset:0
    buffer_load_dwordx4 v[76:79], v139, s[20:23], s98 offen offset:256
    buffer_load_dwordx4 v[80:83], v139, s[20:23], s98 offen offset:512
    buffer_load_dwordx4 v[84:87], v139, s[20:23], s98 offen offset:768
    s_barrier
    v_mov_b32 v144, 3072
    ds_read_b32 v145, v144
    v_lshlrev_b32 v144, 8, v7
    v_lshl_add_u32 v144, v3, 4, v144
    ds_read_b128 v[160:163], v144 offset:2048
    ds_read_b128 v[164:167], v144 offset:2112
    ds_read_b128 v[168:171], v144 offset:2176
    ds_read_b128 v[172:175], v144 offset:2240
    v_mov_b32 v176, 0
    v_mov_b32 v177, 0
    v_mov_b32 v178, 0
    v_mov_b32 v179, 0
    v_mov_b32 v180, 0
    v_mov_b32 v181, 0
    v_mov_b32 v182, 0
    v_mov_b32 v183, 0
    s_waitcnt vmcnt(8) lgkmcnt(0)
    v_readfirstlane_b32 s97, v145
    v_mfma_f32_16x16x32_bf16 v[176:179], v[24:27], v[160:163], v[176:179]
    v_mfma_f32_16x16x32_bf16 v[176:179], v[28:31], v[164:167], v[176:179]
    v_mfma_f32_16x16x32_bf16 v[176:179], v[32:35], v[168:171], v[176:179]
    v_mfma_f32_16x16x32_bf16 v[176:179], v[36:39], v[172:175], v[176:179]
    v_mfma_f32_16x16x32_bf16 v[180:183], v[40:43], v[160:163], v[180:183]
    v_mfma_f32_16x16x32_bf16 v[180:183], v[44:47], v[164:167], v[180:183]
    v_mfma_f32_16x16x32_bf16 v[180:183], v[48:51], v[168:171], v[180:183]
    v_mfma_f32_16x16x32_bf16 v[180:183], v[52:55], v[172:175], v[180:183]
    s_mov_b32 s76, 1035273459
    s_mov_b32 s77, 1069066811
    v_mov_b32 v224, 0
    v_mov_b32 v225, 0
    v_mov_b32 v226, 0
    v_mov_b32 v227, 0
    v_mov_b32 v228, 0
    v_mov_b32 v229, 0
    v_mov_b32 v230, 0
    v_mov_b32 v231, 0
    v_mov_b32 v232, 0
    v_mov_b32 v233, 0
    v_mov_b32 v234, 0
    v_mov_b32 v235, 0
    v_mov_b32 v236, 0
    v_mov_b32 v237, 0
    v_mov_b32 v238, 0
    v_mov_b32 v239, 0
    v_mov_b32 v240, 0
    v_mov_b32 v241, 0
    v_mov_b32 v242, 0
    v_mov_b32 v243, 0
    v_mov_b32 v244, 0
    v_mov_b32 v245, 0
    v_mov_b32 v246, 0
    v_mov_b32 v247, 0
    v_mov_b32 v248, 0
    v_mov_b32 v249, 0
    v_mov_b32 v250, 0
    v_mov_b32 v251, 0
    v_mov_b32 v252, 0
    v_mov_b32 v253, 0
    v_mov_b32 v254, 0
    v_mov_b32 v255, 0
    s_nop 1
    v_cvt_pk_bf16_f32 v176, v176, v176
    v_lshlrev_b32 v176, 16, v176
    v_mul_f32 v176, s76, v176
    v_cvt_pk_bf16_f32 v176, v176, v176
    v_lshlrev_b32 v176, 16, v176
    v_cvt_pk_bf16_f32 v177, v177, v177
    v_lshlrev_b32 v177, 16, v177
    v_mul_f32 v177, s76, v177
    v_cvt_pk_bf16_f32 v177, v177, v177
    v_lshlrev_b32 v177, 16, v177
    v_cvt_pk_bf16_f32 v178, v178, v178
    v_lshlrev_b32 v178, 16, v178
    v_mul_f32 v178, s76, v178
    v_cvt_pk_bf16_f32 v178, v178, v178
    v_lshlrev_b32 v178, 16, v178
    v_cvt_pk_bf16_f32 v179, v179, v179
    v_lshlrev_b32 v179, 16, v179
    v_mul_f32 v179, s76, v179
    v_cvt_pk_bf16_f32 v179, v179, v179
    v_lshlrev_b32 v179, 16, v179
    v_cvt_pk_bf16_f32 v180, v180, v180
    v_lshlrev_b32 v180, 16, v180
    v_mul_f32 v180, s76, v180
    v_cvt_pk_bf16_f32 v180, v180, v180
    v_lshlrev_b32 v180, 16, v180
    v_cvt_pk_bf16_f32 v181, v181, v181
    v_lshlrev_b32 v181, 16, v181
    v_mul_f32 v181, s76, v181
    v_cvt_pk_bf16_f32 v181, v181, v181
    v_lshlrev_b32 v181, 16, v181
    v_cvt_pk_bf16_f32 v182, v182, v182
    v_lshlrev_b32 v182, 16, v182
    v_mul_f32 v182, s76, v182
    v_cvt_pk_bf16_f32 v182, v182, v182
    v_lshlrev_b32 v182, 16, v182
    v_cvt_pk_bf16_f32 v183, v183, v183
    v_lshlrev_b32 v183, 16, v183
    v_mul_f32 v183, s76, v183
    v_cvt_pk_bf16_f32 v183, v183, v183
    v_lshlrev_b32 v183, 16, v183
    v_max3_f32 v184, v176, v177, v178
    v_max3_f32 v185, v179, v180, v181
    v_max3_f32 v184, v184, v182, v183
    v_max_f32 v184, v184, v185
    v_mov_b32 v185, v184
    s_nop 1
    v_permlane32_swap_b32 v184, v185
    s_nop 1
    v_max_f32 v184, v184, v185
    v_mov_b32 v185, v184
    s_nop 1
    v_permlane16_swap_b32 v184, v185
    s_nop 1
    v_max_f32 v184, v184, v185
    v_mul_f32 v185, s77, v184
    v_fma_f32 v176, v176, s77, -v185
    v_fma_f32 v177, v177, s77, -v185
    v_fma_f32 v178, v178, s77, -v185
    v_fma_f32 v179, v179, s77, -v185
    v_fma_f32 v180, v180, s77, -v185
    v_fma_f32 v181, v181, s77, -v185
    v_fma_f32 v182, v182, s77, -v185
    v_fma_f32 v183, v183, s77, -v185
    v_exp_f32 v176, v176
    v_exp_f32 v177, v177
    v_exp_f32 v178, v178
    v_exp_f32 v179, v179
    v_exp_f32 v180, v180
    v_exp_f32 v181, v181
    v_exp_f32 v182, v182
    v_exp_f32 v183, v183
    s_nop 0
    v_add_f32 v185, v176, v177
    v_add_f32 v185, v185, v178
    v_add_f32 v185, v185, v179
    v_add_f32 v185, v185, v180
    v_add_f32 v185, v185, v181
    v_add_f32 v185, v185, v182
    v_add_f32 v185, v185, v183
    v_mov_b32_dpp v192, v176 quad_perm:[0,0,0,0] row_mask:0xf bank_mask:0xf
    v_mov_b32_dpp v193, v176 quad_perm:[1,1,1,1] row_mask:0xf bank_mask:0xf
    v_mov_b32_dpp v194, v176 quad_perm:[2,2,2,2] row_mask:0xf bank_mask:0xf
    v_mov_b32_dpp v195, v176 quad_perm:[3,3,3,3] row_mask:0xf bank_mask:0xf
    v_mov_b32_dpp v196, v177 quad_perm:[0,0,0,0] row_mask:0xf bank_mask:0xf
    v_mov_b32_dpp v197, v177 quad_perm:[1,1,1,1] row_mask:0xf bank_mask:0xf
    v_mov_b32_dpp v198, v177 quad_perm:[2,2,2,2] row_mask:0xf bank_mask:0xf
    v_mov_b32_dpp v199, v177 quad_perm:[3,3,3,3] row_mask:0xf bank_mask:0xf
    v_mov_b32_dpp v200, v178 quad_perm:[0,0,0,0] row_mask:0xf bank_mask:0xf
    v_mov_b32_dpp v201, v178 quad_perm:[1,1,1,1] row_mask:0xf bank_mask:0xf
    v_mov_b32_dpp v202, v178 quad_perm:[2,2,2,2] row_mask:0xf bank_mask:0xf
    v_mov_b32_dpp v203, v178 quad_perm:[3,3,3,3] row_mask:0xf bank_mask:0xf
    v_mov_b32_dpp v204, v179 quad_perm:[0,0,0,0] row_mask:0xf bank_mask:0xf
    v_mov_b32_dpp v205, v179 quad_perm:[1,1,1,1] row_mask:0xf bank_mask:0xf
    v_mov_b32_dpp v206, v179 quad_perm:[2,2,2,2] row_mask:0xf bank_mask:0xf
    v_mov_b32_dpp v207, v179 quad_perm:[3,3,3,3] row_mask:0xf bank_mask:0xf
    v_mov_b32_dpp v208, v180 quad_perm:[0,0,0,0] row_mask:0xf bank_mask:0xf
    v_mov_b32_dpp v209, v180 quad_perm:[1,1,1,1] row_mask:0xf bank_mask:0xf
    v_mov_b32_dpp v210, v180 quad_perm:[2,2,2,2] row_mask:0xf bank_mask:0xf
    v_mov_b32_dpp v211, v180 quad_perm:[3,3,3,3] row_mask:0xf bank_mask:0xf
    v_mov_b32_dpp v212, v181 quad_perm:[0,0,0,0] row_mask:0xf bank_mask:0xf
    v_mov_b32_dpp v213, v181 quad_perm:[1,1,1,1] row_mask:0xf bank_mask:0xf
    v_mov_b32_dpp v214, v181 quad_perm:[2,2,2,2] row_mask:0xf bank_mask:0xf
    v_mov_b32_dpp v215, v181 quad_perm:[3,3,3,3] row_mask:0xf bank_mask:0xf
    v_mov_b32_dpp v216, v182 quad_perm:[0,0,0,0] row_mask:0xf bank_mask:0xf
    v_mov_b32_dpp v217, v182 quad_perm:[1,1,1,1] row_mask:0xf bank_mask:0xf
    v_mov_b32_dpp v218, v182 quad_perm:[2,2,2,2] row_mask:0xf bank_mask:0xf
    v_mov_b32_dpp v219, v182 quad_perm:[3,3,3,3] row_mask:0xf bank_mask:0xf
    v_mov_b32_dpp v220, v183 quad_perm:[0,0,0,0] row_mask:0xf bank_mask:0xf
    v_mov_b32_dpp v221, v183 quad_perm:[1,1,1,1] row_mask:0xf bank_mask:0xf
    v_mov_b32_dpp v222, v183 quad_perm:[2,2,2,2] row_mask:0xf bank_mask:0xf
    v_mov_b32_dpp v223, v183 quad_perm:[3,3,3,3] row_mask:0xf bank_mask:0xf
    v_mov_b32 v186, v185
    s_nop 1
    v_permlane32_swap_b32 v185, v186
    s_nop 1
    v_add_f32 v185, v185, v186
    v_mov_b32 v186, v185
    s_nop 1
    v_permlane16_swap_b32 v185, v186
    s_nop 1
    v_add_f32 v185, v185, v186
    s_waitcnt vmcnt(7)
    v_lshlrev_b32 v160, 16, v56
    v_and_b32 v161, 0xffff0000, v56
    v_lshlrev_b32 v162, 16, v57
    v_and_b32 v163, 0xffff0000, v57
    v_lshlrev_b32 v164, 16, v58
    v_and_b32 v165, 0xffff0000, v58
    v_lshlrev_b32 v166, 16, v59
    v_and_b32 v167, 0xffff0000, v59
    v_pk_fma_f32 v[224:225], v[192:193], v[160:161], v[224:225] op_sel_hi:[0,1,1]
    v_pk_fma_f32 v[226:227], v[192:193], v[162:163], v[226:227] op_sel_hi:[0,1,1]
    v_pk_fma_f32 v[228:229], v[192:193], v[164:165], v[228:229] op_sel_hi:[0,1,1]
    v_pk_fma_f32 v[230:231], v[192:193], v[166:167], v[230:231] op_sel_hi:[0,1,1]
    v_pk_fma_f32 v[232:233], v[192:193], v[160:161], v[232:233] op_sel:[1,0,0] op_sel_hi:[1,1,1]
    v_pk_fma_f32 v[234:235], v[192:193], v[162:163], v[234:235] op_sel:[1,0,0] op_sel_hi:[1,1,1]
    v_pk_fma_f32 v[236:237], v[192:193], v[164:165], v[236:237] op_sel:[1,0,0] op_sel_hi:[1,1,1]
    v_pk_fma_f32 v[238:239], v[192:193], v[166:167], v[238:239] op_sel:[1,0,0] op_sel_hi:[1,1,1]
    v_pk_fma_f32 v[240:241], v[194:195], v[160:161], v[240:241] op_sel_hi:[0,1,1]
    v_pk_fma_f32 v[242:243], v[194:195], v[162:163], v[242:243] op_sel_hi:[0,1,1]
    v_pk_fma_f32 v[244:245], v[194:195], v[164:165], v[244:245] op_sel_hi:[0,1,1]
    v_pk_fma_f32 v[246:247], v[194:195], v[166:167], v[246:247] op_sel_hi:[0,1,1]
    v_pk_fma_f32 v[248:249], v[194:195], v[160:161], v[248:249] op_sel:[1,0,0] op_sel_hi:[1,1,1]
    v_pk_fma_f32 v[250:251], v[194:195], v[162:163], v[250:251] op_sel:[1,0,0] op_sel_hi:[1,1,1]
    v_pk_fma_f32 v[252:253], v[194:195], v[164:165], v[252:253] op_sel:[1,0,0] op_sel_hi:[1,1,1]
    v_pk_fma_f32 v[254:255], v[194:195], v[166:167], v[254:255] op_sel:[1,0,0] op_sel_hi:[1,1,1]
    s_waitcnt vmcnt(6)
    v_lshlrev_b32 v160, 16, v60
    v_and_b32 v161, 0xffff0000, v60
    v_lshlrev_b32 v162, 16, v61
    v_and_b32 v163, 0xffff0000, v61
    v_lshlrev_b32 v164, 16, v62
    v_and_b32 v165, 0xffff0000, v62
    v_lshlrev_b32 v166, 16, v63
    v_and_b32 v167, 0xffff0000, v63
    v_pk_fma_f32 v[224:225], v[196:197], v[160:161], v[224:225] op_sel_hi:[0,1,1]
    v_pk_fma_f32 v[226:227], v[196:197], v[162:163], v[226:227] op_sel_hi:[0,1,1]
    v_pk_fma_f32 v[228:229], v[196:197], v[164:165], v[228:229] op_sel_hi:[0,1,1]
    v_pk_fma_f32 v[230:231], v[196:197], v[166:167], v[230:231] op_sel_hi:[0,1,1]
    v_pk_fma_f32 v[232:233], v[196:197], v[160:161], v[232:233] op_sel:[1,0,0] op_sel_hi:[1,1,1]
    v_pk_fma_f32 v[234:235], v[196:197], v[162:163], v[234:235] op_sel:[1,0,0] op_sel_hi:[1,1,1]
    v_pk_fma_f32 v[236:237], v[196:197], v[164:165], v[236:237] op_sel:[1,0,0] op_sel_hi:[1,1,1]
    v_pk_fma_f32 v[238:239], v[196:197], v[166:167], v[238:239] op_sel:[1,0,0] op_sel_hi:[1,1,1]
    v_pk_fma_f32 v[240:241], v[198:199], v[160:161], v[240:241] op_sel_hi:[0,1,1]
    v_pk_fma_f32 v[242:243], v[198:199], v[162:163], v[242:243] op_sel_hi:[0,1,1]
    v_pk_fma_f32 v[244:245], v[198:199], v[164:165], v[244:245] op_sel_hi:[0,1,1]
    v_pk_fma_f32 v[246:247], v[198:199], v[166:167], v[246:247] op_sel_hi:[0,1,1]
    v_pk_fma_f32 v[248:249], v[198:199], v[160:161], v[248:249] op_sel:[1,0,0] op_sel_hi:[1,1,1]
    v_pk_fma_f32 v[250:251], v[198:199], v[162:163], v[250:251] op_sel:[1,0,0] op_sel_hi:[1,1,1]
    v_pk_fma_f32 v[252:253], v[198:199], v[164:165], v[252:253] op_sel:[1,0,0] op_sel_hi:[1,1,1]
    v_pk_fma_f32 v[254:255], v[198:199], v[166:167], v[254:255] op_sel:[1,0,0] op_sel_hi:[1,1,1]
    s_waitcnt vmcnt(5)
    v_lshlrev_b32 v160, 16, v64
    v_and_b32 v161, 0xffff0000, v64
    v_lshlrev_b32 v162, 16, v65
    v_and_b32 v163, 0xffff0000, v65
    v_lshlrev_b32 v164, 16, v66
    v_and_b32 v165, 0xffff0000, v66
    v_lshlrev_b32 v166, 16, v67
    v_and_b32 v167, 0xffff0000, v67
    v_pk_fma_f32 v[224:225], v[200:201], v[160:161], v[224:225] op_sel_hi:[0,1,1]
    v_pk_fma_f32 v[226:227], v[200:201], v[162:163], v[226:227] op_sel_hi:[0,1,1]
    v_pk_fma_f32 v[228:229], v[200:201], v[164:165], v[228:229] op_sel_hi:[0,1,1]
    v_pk_fma_f32 v[230:231], v[200:201], v[166:167], v[230:231] op_sel_hi:[0,1,1]
    v_pk_fma_f32 v[232:233], v[200:201], v[160:161], v[232:233] op_sel:[1,0,0] op_sel_hi:[1,1,1]
    v_pk_fma_f32 v[234:235], v[200:201], v[162:163], v[234:235] op_sel:[1,0,0] op_sel_hi:[1,1,1]
    v_pk_fma_f32 v[236:237], v[200:201], v[164:165], v[236:237] op_sel:[1,0,0] op_sel_hi:[1,1,1]
    v_pk_fma_f32 v[238:239], v[200:201], v[166:167], v[238:239] op_sel:[1,0,0] op_sel_hi:[1,1,1]
    v_pk_fma_f32 v[240:241], v[202:203], v[160:161], v[240:241] op_sel_hi:[0,1,1]
    v_pk_fma_f32 v[242:243], v[202:203], v[162:163], v[242:243] op_sel_hi:[0,1,1]
    v_pk_fma_f32 v[244:245], v[202:203], v[164:165], v[244:245] op_sel_hi:[0,1,1]
    v_pk_fma_f32 v[246:247], v[202:203], v[166:167], v[246:247] op_sel_hi:[0,1,1]
    v_pk_fma_f32 v[248:249], v[202:203], v[160:161], v[248:249] op_sel:[1,0,0] op_sel_hi:[1,1,1]
    v_pk_fma_f32 v[250:251], v[202:203], v[162:163], v[250:251] op_sel:[1,0,0] op_sel_hi:[1,1,1]
    v_pk_fma_f32 v[252:253], v[202:203], v[164:165], v[252:253] op_sel:[1,0,0] op_sel_hi:[1,1,1]
    v_pk_fma_f32 v[254:255], v[202:203], v[166:167], v[254:255] op_sel:[1,0,0] op_sel_hi:[1,1,1]
    s_waitcnt vmcnt(4)
    v_lshlrev_b32 v160, 16, v68
    v_and_b32 v161, 0xffff0000, v68
    v_lshlrev_b32 v162, 16, v69
    v_and_b32 v163, 0xffff0000, v69
    v_lshlrev_b32 v164, 16, v70
    v_and_b32 v165, 0xffff0000, v70
    v_lshlrev_b32 v166, 16, v71
    v_and_b32 v167, 0xffff0000, v71
    v_pk_fma_f32 v[224:225], v[204:205], v[160:161], v[224:225] op_sel_hi:[0,1,1]
    v_pk_fma_f32 v[226:227], v[204:205], v[162:163], v[226:227] op_sel_hi:[0,1,1]
    v_pk_fma_f32 v[228:229], v[204:205], v[164:165], v[228:229] op_sel_hi:[0,1,1]
    v_pk_fma_f32 v[230:231], v[204:205], v[166:167], v[230:231] op_sel_hi:[0,1,1]
    v_pk_fma_f32 v[232:233], v[204:205], v[160:161], v[232:233] op_sel:[1,0,0] op_sel_hi:[1,1,1]
    v_pk_fma_f32 v[234:235], v[204:205], v[162:163], v[234:235] op_sel:[1,0,0] op_sel_hi:[1,1,1]
    v_pk_fma_f32 v[236:237], v[204:205], v[164:165], v[236:237] op_sel:[1,0,0] op_sel_hi:[1,1,1]
    v_pk_fma_f32 v[238:239], v[204:205], v[166:167], v[238:239] op_sel:[1,0,0] op_sel_hi:[1,1,1]
    v_pk_fma_f32 v[240:241], v[206:207], v[160:161], v[240:241] op_sel_hi:[0,1,1]
    v_pk_fma_f32 v[242:243], v[206:207], v[162:163], v[242:243] op_sel_hi:[0,1,1]
    v_pk_fma_f32 v[244:245], v[206:207], v[164:165], v[244:245] op_sel_hi:[0,1,1]
    v_pk_fma_f32 v[246:247], v[206:207], v[166:167], v[246:247] op_sel_hi:[0,1,1]
    v_pk_fma_f32 v[248:249], v[206:207], v[160:161], v[248:249] op_sel:[1,0,0] op_sel_hi:[1,1,1]
    v_pk_fma_f32 v[250:251], v[206:207], v[162:163], v[250:251] op_sel:[1,0,0] op_sel_hi:[1,1,1]
    v_pk_fma_f32 v[252:253], v[206:207], v[164:165], v[252:253] op_sel:[1,0,0] op_sel_hi:[1,1,1]
    v_pk_fma_f32 v[254:255], v[206:207], v[166:167], v[254:255] op_sel:[1,0,0] op_sel_hi:[1,1,1]
    s_waitcnt vmcnt(3)
    v_lshlrev_b32 v160, 16, v72
    v_and_b32 v161, 0xffff0000, v72
    v_lshlrev_b32 v162, 16, v73
    v_and_b32 v163, 0xffff0000, v73
    v_lshlrev_b32 v164, 16, v74
    v_and_b32 v165, 0xffff0000, v74
    v_lshlrev_b32 v166, 16, v75
    v_and_b32 v167, 0xffff0000, v75
    v_pk_fma_f32 v[224:225], v[208:209], v[160:161], v[224:225] op_sel_hi:[0,1,1]
    v_pk_fma_f32 v[226:227], v[208:209], v[162:163], v[226:227] op_sel_hi:[0,1,1]
    v_pk_fma_f32 v[228:229], v[208:209], v[164:165], v[228:229] op_sel_hi:[0,1,1]
    v_pk_fma_f32 v[230:231], v[208:209], v[166:167], v[230:231] op_sel_hi:[0,1,1]
    v_pk_fma_f32 v[232:233], v[208:209], v[160:161], v[232:233] op_sel:[1,0,0] op_sel_hi:[1,1,1]
    v_pk_fma_f32 v[234:235], v[208:209], v[162:163], v[234:235] op_sel:[1,0,0] op_sel_hi:[1,1,1]
    v_pk_fma_f32 v[236:237], v[208:209], v[164:165], v[236:237] op_sel:[1,0,0] op_sel_hi:[1,1,1]
    v_pk_fma_f32 v[238:239], v[208:209], v[166:167], v[238:239] op_sel:[1,0,0] op_sel_hi:[1,1,1]
    v_pk_fma_f32 v[240:241], v[210:211], v[160:161], v[240:241] op_sel_hi:[0,1,1]
    v_pk_fma_f32 v[242:243], v[210:211], v[162:163], v[242:243] op_sel_hi:[0,1,1]
    v_pk_fma_f32 v[244:245], v[210:211], v[164:165], v[244:245] op_sel_hi:[0,1,1]
    v_pk_fma_f32 v[246:247], v[210:211], v[166:167], v[246:247] op_sel_hi:[0,1,1]
    v_pk_fma_f32 v[248:249], v[210:211], v[160:161], v[248:249] op_sel:[1,0,0] op_sel_hi:[1,1,1]
    v_pk_fma_f32 v[250:251], v[210:211], v[162:163], v[250:251] op_sel:[1,0,0] op_sel_hi:[1,1,1]
    v_pk_fma_f32 v[252:253], v[210:211], v[164:165], v[252:253] op_sel:[1,0,0] op_sel_hi:[1,1,1]
    v_pk_fma_f32 v[254:255], v[210:211], v[166:167], v[254:255] op_sel:[1,0,0] op_sel_hi:[1,1,1]
    s_waitcnt vmcnt(2)
    v_lshlrev_b32 v160, 16, v76
    v_and_b32 v161, 0xffff0000, v76
    v_lshlrev_b32 v162, 16, v77
    v_and_b32 v163, 0xffff0000, v77
    v_lshlrev_b32 v164, 16, v78
    v_and_b32 v165, 0xffff0000, v78
    v_lshlrev_b32 v166, 16, v79
    v_and_b32 v167, 0xffff0000, v79
    v_pk_fma_f32 v[224:225], v[212:213], v[160:161], v[224:225] op_sel_hi:[0,1,1]
    v_pk_fma_f32 v[226:227], v[212:213], v[162:163], v[226:227] op_sel_hi:[0,1,1]
    v_pk_fma_f32 v[228:229], v[212:213], v[164:165], v[228:229] op_sel_hi:[0,1,1]
    v_pk_fma_f32 v[230:231], v[212:213], v[166:167], v[230:231] op_sel_hi:[0,1,1]
    v_pk_fma_f32 v[232:233], v[212:213], v[160:161], v[232:233] op_sel:[1,0,0] op_sel_hi:[1,1,1]
    v_pk_fma_f32 v[234:235], v[212:213], v[162:163], v[234:235] op_sel:[1,0,0] op_sel_hi:[1,1,1]
    v_pk_fma_f32 v[236:237], v[212:213], v[164:165], v[236:237] op_sel:[1,0,0] op_sel_hi:[1,1,1]
    v_pk_fma_f32 v[238:239], v[212:213], v[166:167], v[238:239] op_sel:[1,0,0] op_sel_hi:[1,1,1]
    v_pk_fma_f32 v[240:241], v[214:215], v[160:161], v[240:241] op_sel_hi:[0,1,1]
    v_pk_fma_f32 v[242:243], v[214:215], v[162:163], v[242:243] op_sel_hi:[0,1,1]
    v_pk_fma_f32 v[244:245], v[214:215], v[164:165], v[244:245] op_sel_hi:[0,1,1]
    v_pk_fma_f32 v[246:247], v[214:215], v[166:167], v[246:247] op_sel_hi:[0,1,1]
    v_pk_fma_f32 v[248:249], v[214:215], v[160:161], v[248:249] op_sel:[1,0,0] op_sel_hi:[1,1,1]
    v_pk_fma_f32 v[250:251], v[214:215], v[162:163], v[250:251] op_sel:[1,0,0] op_sel_hi:[1,1,1]
    v_pk_fma_f32 v[252:253], v[214:215], v[164:165], v[252:253] op_sel:[1,0,0] op_sel_hi:[1,1,1]
    v_pk_fma_f32 v[254:255], v[214:215], v[166:167], v[254:255] op_sel:[1,0,0] op_sel_hi:[1,1,1]
    s_waitcnt vmcnt(1)
    v_lshlrev_b32 v160, 16, v80
    v_and_b32 v161, 0xffff0000, v80
    v_lshlrev_b32 v162, 16, v81
    v_and_b32 v163, 0xffff0000, v81
    v_lshlrev_b32 v164, 16, v82
    v_and_b32 v165, 0xffff0000, v82
    v_lshlrev_b32 v166, 16, v83
    v_and_b32 v167, 0xffff0000, v83
    v_pk_fma_f32 v[224:225], v[216:217], v[160:161], v[224:225] op_sel_hi:[0,1,1]
    v_pk_fma_f32 v[226:227], v[216:217], v[162:163], v[226:227] op_sel_hi:[0,1,1]
    v_pk_fma_f32 v[228:229], v[216:217], v[164:165], v[228:229] op_sel_hi:[0,1,1]
    v_pk_fma_f32 v[230:231], v[216:217], v[166:167], v[230:231] op_sel_hi:[0,1,1]
    v_pk_fma_f32 v[232:233], v[216:217], v[160:161], v[232:233] op_sel:[1,0,0] op_sel_hi:[1,1,1]
    v_pk_fma_f32 v[234:235], v[216:217], v[162:163], v[234:235] op_sel:[1,0,0] op_sel_hi:[1,1,1]
    v_pk_fma_f32 v[236:237], v[216:217], v[164:165], v[236:237] op_sel:[1,0,0] op_sel_hi:[1,1,1]
    v_pk_fma_f32 v[238:239], v[216:217], v[166:167], v[238:239] op_sel:[1,0,0] op_sel_hi:[1,1,1]
    v_pk_fma_f32 v[240:241], v[218:219], v[160:161], v[240:241] op_sel_hi:[0,1,1]
    v_pk_fma_f32 v[242:243], v[218:219], v[162:163], v[242:243] op_sel_hi:[0,1,1]
    v_pk_fma_f32 v[244:245], v[218:219], v[164:165], v[244:245] op_sel_hi:[0,1,1]
    v_pk_fma_f32 v[246:247], v[218:219], v[166:167], v[246:247] op_sel_hi:[0,1,1]
    v_pk_fma_f32 v[248:249], v[218:219], v[160:161], v[248:249] op_sel:[1,0,0] op_sel_hi:[1,1,1]
    v_pk_fma_f32 v[250:251], v[218:219], v[162:163], v[250:251] op_sel:[1,0,0] op_sel_hi:[1,1,1]
    v_pk_fma_f32 v[252:253], v[218:219], v[164:165], v[252:253] op_sel:[1,0,0] op_sel_hi:[1,1,1]
    v_pk_fma_f32 v[254:255], v[218:219], v[166:167], v[254:255] op_sel:[1,0,0] op_sel_hi:[1,1,1]
    s_waitcnt vmcnt(0)
    v_lshlrev_b32 v160, 16, v84
    v_and_b32 v161, 0xffff0000, v84
    v_lshlrev_b32 v162, 16, v85
    v_and_b32 v163, 0xffff0000, v85
    v_lshlrev_b32 v164, 16, v86
    v_and_b32 v165, 0xffff0000, v86
    v_lshlrev_b32 v166, 16, v87
    v_and_b32 v167, 0xffff0000, v87
    v_pk_fma_f32 v[224:225], v[220:221], v[160:161], v[224:225] op_sel_hi:[0,1,1]
    v_pk_fma_f32 v[226:227], v[220:221], v[162:163], v[226:227] op_sel_hi:[0,1,1]
    v_pk_fma_f32 v[228:229], v[220:221], v[164:165], v[228:229] op_sel_hi:[0,1,1]
    v_pk_fma_f32 v[230:231], v[220:221], v[166:167], v[230:231] op_sel_hi:[0,1,1]
    v_pk_fma_f32 v[232:233], v[220:221], v[160:161], v[232:233] op_sel:[1,0,0] op_sel_hi:[1,1,1]
    v_pk_fma_f32 v[234:235], v[220:221], v[162:163], v[234:235] op_sel:[1,0,0] op_sel_hi:[1,1,1]
    v_pk_fma_f32 v[236:237], v[220:221], v[164:165], v[236:237] op_sel:[1,0,0] op_sel_hi:[1,1,1]
    v_pk_fma_f32 v[238:239], v[220:221], v[166:167], v[238:239] op_sel:[1,0,0] op_sel_hi:[1,1,1]
    v_pk_fma_f32 v[240:241], v[222:223], v[160:161], v[240:241] op_sel_hi:[0,1,1]
    v_pk_fma_f32 v[242:243], v[222:223], v[162:163], v[242:243] op_sel_hi:[0,1,1]
    v_pk_fma_f32 v[244:245], v[222:223], v[164:165], v[244:245] op_sel_hi:[0,1,1]
    v_pk_fma_f32 v[246:247], v[222:223], v[166:167], v[246:247] op_sel_hi:[0,1,1]
    v_pk_fma_f32 v[248:249], v[222:223], v[160:161], v[248:249] op_sel:[1,0,0] op_sel_hi:[1,1,1]
    v_pk_fma_f32 v[250:251], v[222:223], v[162:163], v[250:251] op_sel:[1,0,0] op_sel_hi:[1,1,1]
    v_pk_fma_f32 v[252:253], v[222:223], v[164:165], v[252:253] op_sel:[1,0,0] op_sel_hi:[1,1,1]
    v_pk_fma_f32 v[254:255], v[222:223], v[166:167], v[254:255] op_sel:[1,0,0] op_sel_hi:[1,1,1]
    s_nop 1
    v_permlane32_swap_b32 v224, v240
    v_permlane32_swap_b32 v232, v248
    v_permlane32_swap_b32 v225, v241
    v_permlane32_swap_b32 v233, v249
    v_permlane32_swap_b32 v226, v242
    v_permlane32_swap_b32 v234, v250
    v_permlane32_swap_b32 v227, v243
    v_permlane32_swap_b32 v235, v251
    v_permlane32_swap_b32 v228, v244
    v_permlane32_swap_b32 v236, v252
    v_permlane32_swap_b32 v229, v245
    v_permlane32_swap_b32 v237, v253
    v_permlane32_swap_b32 v230, v246
    v_permlane32_swap_b32 v238, v254
    v_permlane32_swap_b32 v231, v247
    v_permlane32_swap_b32 v239, v255
    s_nop 1
    v_add_f32 v224, v224, v240
    v_add_f32 v232, v232, v248
    v_add_f32 v225, v225, v241
    v_add_f32 v233, v233, v249
    v_add_f32 v226, v226, v242
    v_add_f32 v234, v234, v250
    v_add_f32 v227, v227, v243
    v_add_f32 v235, v235, v251
    v_add_f32 v228, v228, v244
    v_add_f32 v236, v236, v252
    v_add_f32 v229, v229, v245
    v_add_f32 v237, v237, v253
    v_add_f32 v230, v230, v246
    v_add_f32 v238, v238, v254
    v_add_f32 v231, v231, v247
    v_add_f32 v239, v239, v255
    s_nop 1
    v_permlane16_swap_b32 v224, v232
    v_permlane16_swap_b32 v225, v233
    v_permlane16_swap_b32 v226, v234
    v_permlane16_swap_b32 v227, v235
    v_permlane16_swap_b32 v228, v236
    v_permlane16_swap_b32 v229, v237
    v_permlane16_swap_b32 v230, v238
    v_permlane16_swap_b32 v231, v239
    s_nop 1
    v_add_f32 v224, v224, v232
    v_add_f32 v225, v225, v233
    v_add_f32 v226, v226, v234
    v_add_f32 v227, v227, v235
    v_add_f32 v228, v228, v236
    v_add_f32 v229, v229, v237
    v_add_f32 v230, v230, v238
    v_add_f32 v231, v231, v239
    v_lshlrev_b32 v144, 11, v4
    v_lshl_add_u32 v144, v1, 5, v144
    ds_write_b128 v144, v[224:227] offset:8192
    ds_write_b128 v144, v[228:231] offset:8208
    v_lshlrev_b32 v144, 5, v4
    v_lshl_add_u32 v144, v7, 3, v144
    ds_write_b64 v144, v[184:185] offset:40960
    s_waitcnt lgkmcnt(0)
    s_barrier
    v_lshlrev_b32 v144, 9, v4
    v_lshl_add_u32 v144, v1, 3, v144
    ds_read_b64 v[192:193], v144 offset:8192
    ds_read_b64 v[194:195], v144 offset:10240
    ds_read_b64 v[196:197], v144 offset:12288
    ds_read_b64 v[198:199], v144 offset:14336
    v_lshlrev_b32 v145, 3, v4
    ds_read_b64 v[200:201], v145 offset:40960
    ds_read_b64 v[202:203], v145 offset:40992
    ds_read_b64 v[204:205], v145 offset:41024
    ds_read_b64 v[206:207], v145 offset:41056
    v_lshlrev_b32 v146, 15, v4
    v_lshl_add_u32 v146, v1, 4, v146
    s_lshl_b32 s68, s61, 17
    s_lshl_b32 s69, s62, 10
    s_add_u32 s68, s68, s69
    s_add_u32 s68, s68, 131072
    v_lshlrev_b32 v147, 9, v4
    s_lshl_b32 s70, s61, 11
    s_lshl_b32 s69, s62, 4
    s_add_u32 s70, s70, s69
    s_add_u32 s70, s70, 1179648
    s_waitcnt lgkmcnt(0)
    v_max3_f32 v240, v200, v202, v204
    v_max_f32 v240, v240, v206
    v_sub_f32 v208, v200, v240
    v_mul_f32 v208, s77, v208
    v_sub_f32 v210, v202, v240
    v_mul_f32 v210, s77, v210
    v_sub_f32 v212, v204, v240
    v_mul_f32 v212, s77, v212
    v_sub_f32 v214, v206, v240
    v_mul_f32 v214, s77, v214
    v_exp_f32 v208, v208
    v_exp_f32 v210, v210
    v_exp_f32 v212, v212
    v_exp_f32 v214, v214
    s_nop 0
    v_mul_f32 v242, v208, v201
    v_pk_mul_f32 v[216:217], v[208:209], v[192:193] op_sel_hi:[0,1]
    v_fmac_f32 v242, v210, v203
    v_pk_fma_f32 v[216:217], v[210:211], v[194:195], v[216:217] op_sel_hi:[0,1,1]
    v_fmac_f32 v242, v212, v205
    v_pk_fma_f32 v[216:217], v[212:213], v[196:197], v[216:217] op_sel_hi:[0,1,1]
    v_fmac_f32 v242, v214, v207
    v_pk_fma_f32 v[216:217], v[214:215], v[198:199], v[216:217] op_sel_hi:[0,1,1]
    v_mov_b32 v241, s97
    v_mov_b32 v243, s97
    v_mov_b32 v218, v217
    v_mov_b32 v217, s97
    v_mov_b32 v219, s97
    buffer_store_dwordx4 v[216:219], v146, s[40:43], s68 offen sc1
    buffer_store_dwordx4 v[240:243], v147, s[40:43], s70 offen sc1
    s_cmp_lt_u32 s2, 28
    s_cbranch_scc1 ROLEC
    s_cmp_lt_u32 s2, 36
    s_cbranch_scc1 ROLED
    s_cmp_lt_u32 s2, 128
    s_cbranch_scc1 END
    s_sub_u32 s68, s2, 128
    s_lshr_b32 s68, s68, 2
    s_and_b32 s67, s2, 3
    v_lshrrev_b32 v5, 4, v0
    v_and_b32 v6, 15, v0
    v_lshlrev_b32 v148, 10, v5
    v_lshl_add_u32 v148, v6, 4, v148
    s_lshl_b32 s69, s68, 17
    s_lshl_b32 s70, s67, 8
    s_add_u32 s69, s69, s70
    buffer_load_dwordx4 v[88:91], v148, s[28:31], s69 offen
    s_add_u32 s69, s69, 16384
    buffer_load_dwordx4 v[92:95], v148, s[28:31], s69 offen
    s_add_u32 s69, s69, 16384
    buffer_load_dwordx4 v[96:99], v148, s[28:31], s69 offen
    s_add_u32 s69, s69, 16384
    buffer_load_dwordx4 v[100:103], v148, s[28:31], s69 offen
    s_add_u32 s69, s69, 16384
    buffer_load_dwordx4 v[104:107], v148, s[28:31], s69 offen
    s_add_u32 s69, s69, 16384
    buffer_load_dwordx4 v[108:111], v148, s[28:31], s69 offen
    s_add_u32 s69, s69, 16384
    buffer_load_dwordx4 v[112:115], v148, s[28:31], s69 offen
    s_add_u32 s69, s69, 16384
    buffer_load_dwordx4 v[116:119], v148, s[28:31], s69 offen
    v_and_b32 v144, 31, v1
    v_lshlrev_b32 v149, 4, v144
    v_lshlrev_b32 v144, 3, v144
    s_lshl_b32 s69, s68, 9
    s_add_u32 s69, s69, 1179648
    v_lshrrev_b32 v145, 7, v0
    v_and_b32 v146, 127, v0
    v_lshlrev_b32 v147, 14, v145
    v_lshl_add_u32 v147, v146, 3, v147
    v_add_u32 v152, 4096, v147
    v_add_u32 v153, 8192, v147
    v_add_u32 v154, 12288, v147
    v_mov_b32 v151, v147
    s_lshl_b32 s70, s68, 15
    s_add_u32 s70, s70, 131072
    buffer_load_dwordx4 v[8:11], v149, s[40:43], s69 offen sc1
    s_mov_b32 s71, 0
PP1:
    s_waitcnt vmcnt(0)
    v_xor_b32 v250, s97, v9
    v_xor_b32 v251, s97, v11
    v_or_b32 v250, v250, v251
    v_cmp_eq_u32 vcc, 0, v250
    s_nop 4
    s_cmp_eq_u64 vcc, exec
    s_cbranch_scc1 PD1_0
    buffer_load_dwordx4 v[8:11], v149, s[40:43], s69 offen sc1
    s_sleep 1
    s_add_u32 s71, s71, 1
    s_cmp_lt_u32 s71, 0x8000
    s_cbranch_scc1 PP1
PD1_0:
    v_mov_b32 v156, v8
    v_mov_b32 v158, v10
PE1:
    buffer_load_dwordx2 v[192:193], v151, s[40:43], s70 offen offset:0 sc1
    buffer_load_dwordx2 v[194:195], v151, s[40:43], s70 offen offset:1024 sc1
    buffer_load_dwordx2 v[196:197], v151, s[40:43], s70 offen offset:2048 sc1
    buffer_load_dwordx2 v[198:199], v151, s[40:43], s70 offen offset:3072 sc1
    buffer_load_dwordx2 v[200:201], v152, s[40:43], s70 offen offset:0 sc1
    buffer_load_dwordx2 v[202:203], v152, s[40:43], s70 offen offset:1024 sc1
    buffer_load_dwordx2 v[204:205], v152, s[40:43], s70 offen offset:2048 sc1
    buffer_load_dwordx2 v[206:207], v152, s[40:43], s70 offen offset:3072 sc1
    buffer_load_dwordx2 v[208:209], v153, s[40:43], s70 offen offset:0 sc1
    buffer_load_dwordx2 v[210:211], v153, s[40:43], s70 offen offset:1024 sc1
    buffer_load_dwordx2 v[212:213], v153, s[40:43], s70 offen offset:2048 sc1
    buffer_load_dwordx2 v[214:215], v153, s[40:43], s70 offen offset:3072 sc1
    buffer_load_dwordx2 v[216:217], v154, s[40:43], s70 offen offset:0 sc1
    buffer_load_dwordx2 v[218:219], v154, s[40:43], s70 offen offset:1024 sc1
    buffer_load_dwordx2 v[220:221], v154, s[40:43], s70 offen offset:2048 sc1
    buffer_load_dwordx2 v[222:223], v154, s[40:43], s70 offen offset:3072 sc1
    v_mov_b32 v160, v156
    v_mov_b32 v161, v158
    v_mov_b32 v162, v160
    s_nop 1
    v_max_f32_dpp v162, v162, v162 quad_perm:[1,0,3,2] row_mask:0xf bank_mask:0xf
    s_nop 1
    v_max_f32_dpp v162, v162, v162 quad_perm:[2,3,0,1] row_mask:0xf bank_mask:0xf
    s_nop 1
    v_max_f32_dpp v162, v162, v162 row_half_mirror row_mask:0xf bank_mask:0xf
    s_nop 1
    v_max_f32_dpp v162, v162, v162 row_mirror row_mask:0xf bank_mask:0xf
    s_nop 1
    v_readlane_b32 s90, v162, 0
    v_readlane_b32 s91, v162, 16
    v_readlane_b32 s92, v162, 32
    v_readlane_b32 s93, v162, 48
    s_nop 1
    v_mov_b32 v162, s90
    v_max_f32 v162, s91, v162
    v_max_f32 v162, s92, v162
    v_max_f32 v162, s93, v162
    v_sub_f32 v163, v160, v162
    v_mul_f32 v163, s77, v163
    v_exp_f32 v163, v163
    s_nop 0
    v_mul_f32 v162, v163, v161
    s_nop 1
    v_add_f32_dpp v162, v162, v162 quad_perm:[1,0,3,2] row_mask:0xf bank_mask:0xf
    s_nop 1
    v_add_f32_dpp v162, v162, v162 quad_perm:[2,3,0,1] row_mask:0xf bank_mask:0xf
    s_nop 1
    v_add_f32_dpp v162, v162, v162 row_half_mirror row_mask:0xf bank_mask:0xf
    s_nop 1
    v_add_f32_dpp v162, v162, v162 row_mirror row_mask:0xf bank_mask:0xf
    s_nop 1
    v_readlane_b32 s90, v162, 0
    v_readlane_b32 s91, v162, 16
    v_readlane_b32 s92, v162, 32
    v_readlane_b32 s93, v162, 48
    s_nop 1
    v_mov_b32 v162, s90
    v_add_f32 v162, s91, v162
    v_add_f32 v162, s92, v162
    v_add_f32 v162, s93, v162
    v_mul_f32 v162, 0.5, v162
    v_rcp_f32 v164, v162
    s_nop 0
    v_mul_f32 v165, v163, v164
    v_fma_f32 v166, -v165, v162, v163
    v_fma_f32 v165, v166, v164, v165
    v_lshrrev_b32 v144, 1, v144
    ds_write_b32 v144, v165 offset:2048
    s_waitcnt lgkmcnt(0)
    v_lshlrev_b32 v144, 6, v145
    ds_read_b128 v[228:231], v144 offset:2048
    ds_read_b128 v[232:235], v144 offset:2064
    ds_read_b128 v[236:239], v144 offset:2080
    ds_read_b128 v[240:243], v144 offset:2096
    s_waitcnt vmcnt(0)
    v_xor_b32 v250, s97, v193
    v_xor_b32 v251, s97, v195
    v_or_b32 v250, v250, v251
    v_xor_b32 v251, s97, v197
    v_or_b32 v250, v250, v251
    v_xor_b32 v251, s97, v199
    v_or_b32 v250, v250, v251
    v_xor_b32 v251, s97, v201
    v_or_b32 v250, v250, v251
    v_xor_b32 v251, s97, v203
    v_or_b32 v250, v250, v251
    v_xor_b32 v251, s97, v205
    v_or_b32 v250, v250, v251
    v_xor_b32 v251, s97, v207
    v_or_b32 v250, v250, v251
    v_xor_b32 v251, s97, v209
    v_or_b32 v250, v250, v251
    v_xor_b32 v251, s97, v211
    v_or_b32 v250, v250, v251
    v_xor_b32 v251, s97, v213
    v_or_b32 v250, v250, v251
    v_xor_b32 v251, s97, v215
    v_or_b32 v250, v250, v251
    v_xor_b32 v251, s97, v217
    v_or_b32 v250, v250, v251
    v_xor_b32 v251, s97, v219
    v_or_b32 v250, v250, v251
    v_xor_b32 v251, s97, v221
    v_or_b32 v250, v250, v251
    v_xor_b32 v251, s97, v223
    v_or_b32 v250, v250, v251
    v_cmp_eq_u32 vcc, 0, v250
    s_nop 4
    s_cmp_eq_u64 vcc, exec
    s_cbranch_scc1 BOK
    s_mov_b32 s71, 0
GL2:
    buffer_load_dwordx2 v[192:193], v151, s[40:43], s70 offen offset:0 sc1
    buffer_load_dwordx2 v[194:195], v151, s[40:43], s70 offen offset:1024 sc1
    buffer_load_dwordx2 v[196:197], v151, s[40:43], s70 offen offset:2048 sc1
    buffer_load_dwordx2 v[198:199], v151, s[40:43], s70 offen offset:3072 sc1
    buffer_load_dwordx2 v[200:201], v152, s[40:43], s70 offen offset:0 sc1
    buffer_load_dwordx2 v[202:203], v152, s[40:43], s70 offen offset:1024 sc1
    buffer_load_dwordx2 v[204:205], v152, s[40:43], s70 offen offset:2048 sc1
    buffer_load_dwordx2 v[206:207], v152, s[40:43], s70 offen offset:3072 sc1
    buffer_load_dwordx2 v[208:209], v153, s[40:43], s70 offen offset:0 sc1
    buffer_load_dwordx2 v[210:211], v153, s[40:43], s70 offen offset:1024 sc1
    buffer_load_dwordx2 v[212:213], v153, s[40:43], s70 offen offset:2048 sc1
    buffer_load_dwordx2 v[214:215], v153, s[40:43], s70 offen offset:3072 sc1
    buffer_load_dwordx2 v[216:217], v154, s[40:43], s70 offen offset:0 sc1
    buffer_load_dwordx2 v[218:219], v154, s[40:43], s70 offen offset:1024 sc1
    buffer_load_dwordx2 v[220:221], v154, s[40:43], s70 offen offset:2048 sc1
    buffer_load_dwordx2 v[222:223], v154, s[40:43], s70 offen offset:3072 sc1
    s_waitcnt vmcnt(0)
    v_xor_b32 v250, s97, v193
    v_xor_b32 v251, s97, v195
    v_or_b32 v250, v250, v251
    v_xor_b32 v251, s97, v197
    v_or_b32 v250, v250, v251
    v_xor_b32 v251, s97, v199
    v_or_b32 v250, v250, v251
    v_xor_b32 v251, s97, v201
    v_or_b32 v250, v250, v251
    v_xor_b32 v251, s97, v203
    v_or_b32 v250, v250, v251
    v_xor_b32 v251, s97, v205
    v_or_b32 v250, v250, v251
    v_xor_b32 v251, s97, v207
    v_or_b32 v250, v250, v251
    v_xor_b32 v251, s97, v209
    v_or_b32 v250, v250, v251
    v_xor_b32 v251, s97, v211
    v_or_b32 v250, v250, v251
    v_xor_b32 v251, s97, v213
    v_or_b32 v250, v250, v251
    v_xor_b32 v251, s97, v215
    v_or_b32 v250, v250, v251
    v_xor_b32 v251, s97, v217
    v_or_b32 v250, v250, v251
    v_xor_b32 v251, s97, v219
    v_or_b32 v250, v250, v251
    v_xor_b32 v251, s97, v221
    v_or_b32 v250, v250, v251
    v_xor_b32 v251, s97, v223
    v_or_b32 v250, v250, v251
    v_cmp_eq_u32 vcc, 0, v250
    s_nop 4
    s_cmp_eq_u64 vcc, exec
    s_cbranch_scc1 GD2
    s_add_u32 s71, s71, 1
    s_cmp_lt_u32 s71, 0x20000
    s_cbranch_scc1 GL2
GD2:
BOK:
    s_waitcnt lgkmcnt(0)
    v_mul_f32 v168, v192, v228
    v_fmac_f32 v168, v194, v229
    v_fmac_f32 v168, v196, v230
    v_fmac_f32 v168, v198, v231
    v_fmac_f32 v168, v200, v232
    v_fmac_f32 v168, v202, v233
    v_fmac_f32 v168, v204, v234
    v_fmac_f32 v168, v206, v235
    v_fmac_f32 v168, v208, v236
    v_fmac_f32 v168, v210, v237
    v_fmac_f32 v168, v212, v238
    v_fmac_f32 v168, v214, v239
    v_fmac_f32 v168, v216, v240
    v_fmac_f32 v168, v218, v241
    v_fmac_f32 v168, v220, v242
    v_fmac_f32 v168, v222, v243
    v_lshlrev_b32 v144, 2, v0
    ds_write_b32 v144, v168 offset:0
    s_waitcnt lgkmcnt(0)
    s_barrier
    v_lshlrev_b32 v144, 2, v5
    ds_read_b32 v176, v144 offset:0
    ds_read_b32 v177, v144 offset:512
    ds_read_b32 v178, v144 offset:64
    ds_read_b32 v179, v144 offset:576
    ds_read_b32 v180, v144 offset:128
    ds_read_b32 v181, v144 offset:640
    ds_read_b32 v182, v144 offset:192
    ds_read_b32 v183, v144 offset:704
    ds_read_b32 v184, v144 offset:256
    ds_read_b32 v185, v144 offset:768
    ds_read_b32 v186, v144 offset:320
    ds_read_b32 v187, v144 offset:832
    ds_read_b32 v188, v144 offset:384
    ds_read_b32 v189, v144 offset:896
    ds_read_b32 v190, v144 offset:448
    ds_read_b32 v191, v144 offset:960
    v_mov_b32 v160, 0
    v_mov_b32 v161, 0
    v_mov_b32 v162, 0
    v_mov_b32 v163, 0
    v_mov_b32 v164, 0
    v_mov_b32 v165, 0
    v_mov_b32 v166, 0
    v_mov_b32 v167, 0
    s_waitcnt lgkmcnt(0)
    v_add_f32 v176, v176, v177
    v_cvt_pk_bf16_f32 v176, v176, v176
    v_lshlrev_b32 v176, 16, v176
    v_add_f32 v178, v178, v179
    v_cvt_pk_bf16_f32 v178, v178, v178
    v_lshlrev_b32 v178, 16, v178
    v_add_f32 v180, v180, v181
    v_cvt_pk_bf16_f32 v180, v180, v180
    v_lshlrev_b32 v180, 16, v180
    v_add_f32 v182, v182, v183
    v_cvt_pk_bf16_f32 v182, v182, v182
    v_lshlrev_b32 v182, 16, v182
    v_add_f32 v184, v184, v185
    v_cvt_pk_bf16_f32 v184, v184, v184
    v_lshlrev_b32 v184, 16, v184
    v_add_f32 v186, v186, v187
    v_cvt_pk_bf16_f32 v186, v186, v186
    v_lshlrev_b32 v186, 16, v186
    v_add_f32 v188, v188, v189
    v_cvt_pk_bf16_f32 v188, v188, v188
    v_lshlrev_b32 v188, 16, v188
    v_add_f32 v190, v190, v191
    v_cvt_pk_bf16_f32 v190, v190, v190
    v_lshlrev_b32 v190, 16, v190
    v_lshlrev_b32 v168, 16, v88
    v_and_b32 v169, 0xffff0000, v88
    v_lshlrev_b32 v170, 16, v89
    v_and_b32 v171, 0xffff0000, v89
    v_lshlrev_b32 v172, 16, v90
    v_and_b32 v173, 0xffff0000, v90
    v_lshlrev_b32 v174, 16, v91
    v_and_b32 v175, 0xffff0000, v91
    v_pk_fma_f32 v[160:161], v[176:177], v[168:169], v[160:161] op_sel_hi:[0,1,1]
    v_pk_fma_f32 v[162:163], v[176:177], v[170:171], v[162:163] op_sel_hi:[0,1,1]
    v_pk_fma_f32 v[164:165], v[176:177], v[172:173], v[164:165] op_sel_hi:[0,1,1]
    v_pk_fma_f32 v[166:167], v[176:177], v[174:175], v[166:167] op_sel_hi:[0,1,1]
    v_lshlrev_b32 v168, 16, v92
    v_and_b32 v169, 0xffff0000, v92
    v_lshlrev_b32 v170, 16, v93
    v_and_b32 v171, 0xffff0000, v93
    v_lshlrev_b32 v172, 16, v94
    v_and_b32 v173, 0xffff0000, v94
    v_lshlrev_b32 v174, 16, v95
    v_and_b32 v175, 0xffff0000, v95
    v_pk_fma_f32 v[160:161], v[178:179], v[168:169], v[160:161] op_sel_hi:[0,1,1]
    v_pk_fma_f32 v[162:163], v[178:179], v[170:171], v[162:163] op_sel_hi:[0,1,1]
    v_pk_fma_f32 v[164:165], v[178:179], v[172:173], v[164:165] op_sel_hi:[0,1,1]
    v_pk_fma_f32 v[166:167], v[178:179], v[174:175], v[166:167] op_sel_hi:[0,1,1]
    v_lshlrev_b32 v168, 16, v96
    v_and_b32 v169, 0xffff0000, v96
    v_lshlrev_b32 v170, 16, v97
    v_and_b32 v171, 0xffff0000, v97
    v_lshlrev_b32 v172, 16, v98
    v_and_b32 v173, 0xffff0000, v98
    v_lshlrev_b32 v174, 16, v99
    v_and_b32 v175, 0xffff0000, v99
    v_pk_fma_f32 v[160:161], v[180:181], v[168:169], v[160:161] op_sel_hi:[0,1,1]
    v_pk_fma_f32 v[162:163], v[180:181], v[170:171], v[162:163] op_sel_hi:[0,1,1]
    v_pk_fma_f32 v[164:165], v[180:181], v[172:173], v[164:165] op_sel_hi:[0,1,1]
    v_pk_fma_f32 v[166:167], v[180:181], v[174:175], v[166:167] op_sel_hi:[0,1,1]
    v_lshlrev_b32 v168, 16, v100
    v_and_b32 v169, 0xffff0000, v100
    v_lshlrev_b32 v170, 16, v101
    v_and_b32 v171, 0xffff0000, v101
    v_lshlrev_b32 v172, 16, v102
    v_and_b32 v173, 0xffff0000, v102
    v_lshlrev_b32 v174, 16, v103
    v_and_b32 v175, 0xffff0000, v103
    v_pk_fma_f32 v[160:161], v[182:183], v[168:169], v[160:161] op_sel_hi:[0,1,1]
    v_pk_fma_f32 v[162:163], v[182:183], v[170:171], v[162:163] op_sel_hi:[0,1,1]
    v_pk_fma_f32 v[164:165], v[182:183], v[172:173], v[164:165] op_sel_hi:[0,1,1]
    v_pk_fma_f32 v[166:167], v[182:183], v[174:175], v[166:167] op_sel_hi:[0,1,1]
    v_lshlrev_b32 v168, 16, v104
    v_and_b32 v169, 0xffff0000, v104
    v_lshlrev_b32 v170, 16, v105
    v_and_b32 v171, 0xffff0000, v105
    v_lshlrev_b32 v172, 16, v106
    v_and_b32 v173, 0xffff0000, v106
    v_lshlrev_b32 v174, 16, v107
    v_and_b32 v175, 0xffff0000, v107
    v_pk_fma_f32 v[160:161], v[184:185], v[168:169], v[160:161] op_sel_hi:[0,1,1]
    v_pk_fma_f32 v[162:163], v[184:185], v[170:171], v[162:163] op_sel_hi:[0,1,1]
    v_pk_fma_f32 v[164:165], v[184:185], v[172:173], v[164:165] op_sel_hi:[0,1,1]
    v_pk_fma_f32 v[166:167], v[184:185], v[174:175], v[166:167] op_sel_hi:[0,1,1]
    v_lshlrev_b32 v168, 16, v108
    v_and_b32 v169, 0xffff0000, v108
    v_lshlrev_b32 v170, 16, v109
    v_and_b32 v171, 0xffff0000, v109
    v_lshlrev_b32 v172, 16, v110
    v_and_b32 v173, 0xffff0000, v110
    v_lshlrev_b32 v174, 16, v111
    v_and_b32 v175, 0xffff0000, v111
    v_pk_fma_f32 v[160:161], v[186:187], v[168:169], v[160:161] op_sel_hi:[0,1,1]
    v_pk_fma_f32 v[162:163], v[186:187], v[170:171], v[162:163] op_sel_hi:[0,1,1]
    v_pk_fma_f32 v[164:165], v[186:187], v[172:173], v[164:165] op_sel_hi:[0,1,1]
    v_pk_fma_f32 v[166:167], v[186:187], v[174:175], v[166:167] op_sel_hi:[0,1,1]
    v_lshlrev_b32 v168, 16, v112
    v_and_b32 v169, 0xffff0000, v112
    v_lshlrev_b32 v170, 16, v113
    v_and_b32 v171, 0xffff0000, v113
    v_lshlrev_b32 v172, 16, v114
    v_and_b32 v173, 0xffff0000, v114
    v_lshlrev_b32 v174, 16, v115
    v_and_b32 v175, 0xffff0000, v115
    v_pk_fma_f32 v[160:161], v[188:189], v[168:169], v[160:161] op_sel_hi:[0,1,1]
    v_pk_fma_f32 v[162:163], v[188:189], v[170:171], v[162:163] op_sel_hi:[0,1,1]
    v_pk_fma_f32 v[164:165], v[188:189], v[172:173], v[164:165] op_sel_hi:[0,1,1]
    v_pk_fma_f32 v[166:167], v[188:189], v[174:175], v[166:167] op_sel_hi:[0,1,1]
    v_lshlrev_b32 v168, 16, v116
    v_and_b32 v169, 0xffff0000, v116
    v_lshlrev_b32 v170, 16, v117
    v_and_b32 v171, 0xffff0000, v117
    v_lshlrev_b32 v172, 16, v118
    v_and_b32 v173, 0xffff0000, v118
    v_lshlrev_b32 v174, 16, v119
    v_and_b32 v175, 0xffff0000, v119
    v_pk_fma_f32 v[160:161], v[190:191], v[168:169], v[160:161] op_sel_hi:[0,1,1]
    v_pk_fma_f32 v[162:163], v[190:191], v[170:171], v[162:163] op_sel_hi:[0,1,1]
    v_pk_fma_f32 v[164:165], v[190:191], v[172:173], v[164:165] op_sel_hi:[0,1,1]
    v_pk_fma_f32 v[166:167], v[190:191], v[174:175], v[166:167] op_sel_hi:[0,1,1]
    v_lshlrev_b32 v144, 9, v5
    v_lshl_add_u32 v144, v6, 5, v144
    ds_write_b128 v144, v[160:163] offset:8192
    ds_write_b128 v144, v[164:167] offset:8208
    s_waitcnt lgkmcnt(0)
    s_barrier
    s_cmp_ge_u32 s60, 2
    s_cbranch_scc1 END
    v_lshlrev_b32 v144, 2, v0
    ds_read_b32 v176, v144 offset:8192
    ds_read_b32 v177, v144 offset:8704
    ds_read_b32 v178, v144 offset:9216
    ds_read_b32 v179, v144 offset:9728
    ds_read_b32 v180, v144 offset:10240
    ds_read_b32 v181, v144 offset:10752
    ds_read_b32 v182, v144 offset:11264
    ds_read_b32 v183, v144 offset:11776
    ds_read_b32 v184, v144 offset:12288
    ds_read_b32 v185, v144 offset:12800
    ds_read_b32 v186, v144 offset:13312
    ds_read_b32 v187, v144 offset:13824
    ds_read_b32 v188, v144 offset:14336
    ds_read_b32 v189, v144 offset:14848
    ds_read_b32 v190, v144 offset:15360
    ds_read_b32 v191, v144 offset:15872
    s_lshl_b32 s69, s68, 12
    s_lshl_b32 s70, s67, 10
    s_add_u32 s69, s69, s70
    s_add_u32 s69, s69, 1196032
    v_lshlrev_b32 v144, 3, v0
    s_waitcnt lgkmcnt(0)
    v_add_f32 v176, v176, v177
    v_add_f32 v176, v176, v178
    v_add_f32 v176, v176, v179
    v_add_f32 v176, v176, v180
    v_add_f32 v176, v176, v181
    v_add_f32 v176, v176, v182
    v_add_f32 v176, v176, v183
    v_add_f32 v176, v176, v184
    v_add_f32 v176, v176, v185
    v_add_f32 v176, v176, v186
    v_add_f32 v176, v176, v187
    v_add_f32 v176, v176, v188
    v_add_f32 v176, v176, v189
    v_add_f32 v176, v176, v190
    v_add_f32 v176, v176, v191
    v_mov_b32 v177, s97
    buffer_store_dwordx2 v[176:177], v144, s[40:43], s69 offen sc1
    s_branch END
ROLEC:
    s_mov_b32 s69, 57344
    v_mul_lo_u32 v148, v5, s69
    v_lshl_add_u32 v148, v6, 4, v148
    s_lshl_b32 s69, s2, 7
    buffer_load_dwordx4 v[8:11], v148, s[32:35], s69 offen
    s_add_u32 s69, s69, 3584
    buffer_load_dwordx4 v[12:15], v148, s[32:35], s69 offen
    s_add_u32 s69, s69, 3584
    buffer_load_dwordx4 v[16:19], v148, s[32:35], s69 offen
    s_add_u32 s69, s69, 3584
    buffer_load_dwordx4 v[20:23], v148, s[32:35], s69 offen
    s_add_u32 s69, s69, 3584
    buffer_load_dwordx4 v[24:27], v148, s[32:35], s69 offen
    s_add_u32 s69, s69, 3584
    buffer_load_dwordx4 v[28:31], v148, s[32:35], s69 offen
    s_add_u32 s69, s69, 3584
    buffer_load_dwordx4 v[32:35], v148, s[32:35], s69 offen
    s_add_u32 s69, s69, 3584
    buffer_load_dwordx4 v[36:39], v148, s[32:35], s69 offen
    s_add_u32 s69, s69, 3584
    buffer_load_dwordx4 v[40:43], v148, s[32:35], s69 offen
    s_add_u32 s69, s69, 3584
    buffer_load_dwordx4 v[44:47], v148, s[32:35], s69 offen
    s_add_u32 s69, s69, 3584
    buffer_load_dwordx4 v[48:51], v148, s[32:35], s69 offen
    s_add_u32 s69, s69, 3584
    buffer_load_dwordx4 v[52:55], v148, s[32:35], s69 offen
    s_add_u32 s69, s69, 3584
    buffer_load_dwordx4 v[56:59], v148, s[32:35], s69 offen
    s_add_u32 s69, s69, 3584
    buffer_load_dwordx4 v[60:63], v148, s[32:35], s69 offen
    s_add_u32 s69, s69, 3584
    buffer_load_dwordx4 v[64:67], v148, s[32:35], s69 offen
    s_add_u32 s69, s69, 3584
    buffer_load_dwordx4 v[68:71], v148, s[32:35], s69 offen
    v_lshlrev_b32 v148, 14, v4
    v_lshl_add_u32 v148, v1, 4, v148
    s_lshl_b32 s69, s2, 16
    buffer_load_dwordx4 v[72:75], v148, s[36:39], s69 offen offset:0
    buffer_load_dwordx4 v[76:79], v148, s[36:39], s69 offen offset:1024
    buffer_load_dwordx4 v[80:83], v148, s[36:39], s69 offen offset:2048
    buffer_load_dwordx4 v[84:87], v148, s[36:39], s69 offen offset:3072
    s_add_u32 s69, s69, 4096
    buffer_load_dwordx4 v[88:91], v148, s[36:39], s69 offen offset:0
    buffer_load_dwordx4 v[92:95], v148, s[36:39], s69 offen offset:1024
    buffer_load_dwordx4 v[96:99], v148, s[36:39], s69 offen offset:2048
    buffer_load_dwordx4 v[100:103], v148, s[36:39], s69 offen offset:3072
    s_add_u32 s69, s69, 4096
    buffer_load_dwordx4 v[104:107], v148, s[36:39], s69 offen offset:0
    buffer_load_dwordx4 v[108:111], v148, s[36:39], s69 offen offset:1024
    buffer_load_dwordx4 v[112:115], v148, s[36:39], s69 offen offset:2048
    buffer_load_dwordx4 v[116:119], v148, s[36:39], s69 offen offset:3072
    s_add_u32 s69, s69, 4096
    buffer_load_dwordx4 v[120:123], v148, s[36:39], s69 offen offset:0
    buffer_load_dwordx4 v[124:127], v148, s[36:39], s69 offen offset:1024
    buffer_load_dwordx4 v[128:131], v148, s[36:39], s69 offen offset:2048
    buffer_load_dwordx4 v[132:135], v148, s[36:39], s69 offen offset:3072
    v_lshlrev_b32 v148, 1, v1
    s_lshl_b32 s69, s2, 7
    buffer_load_ushort v140, v148, s[48:51], s69 offen
    v_lshlrev_b32 v148, 2, v0
    buffer_load_dword v142, v148, s[12:15], 0 offen
    v_lshlrev_b32 v145, 4, v0
    v_lshlrev_b32 v149, 9, v0
    s_mov_b32 s69, 1196032
    buffer_load_dwordx2 v[232:233], v149, s[40:43], s69 offen sc1
    s_mov_b32 s71, 0
PP3:
    s_waitcnt vmcnt(0)
    v_xor_b32 v250, s97, v233
    v_cmp_eq_u32 vcc, 0, v250
    s_nop 4
    s_cmp_eq_u64 vcc, exec
    s_cbranch_scc1 PD3_0
    buffer_load_dwordx2 v[232:233], v149, s[40:43], s69 offen sc1
    s_sleep 1
    s_add_u32 s71, s71, 1
    s_cmp_lt_u32 s71, 0x8000
    s_cbranch_scc1 PP3
PD3_0:
PE3:
    s_barrier
    s_mov_b32 s71, 0
GL4:
    v_mov_b32 v146, 0
    v_mov_b32 v147, 0
    v_mov_b32 v250, 0
    s_mov_b32 s69, 1196032
    buffer_load_dwordx4 v[160:163], v145, s[40:43], s69 offen sc1
    s_add_u32 s69, s69, 4096
    buffer_load_dwordx4 v[164:167], v145, s[40:43], s69 offen sc1
    s_add_u32 s69, s69, 4096
    buffer_load_dwordx4 v[168:171], v145, s[40:43], s69 offen sc1
    s_add_u32 s69, s69, 4096
    buffer_load_dwordx4 v[172:175], v145, s[40:43], s69 offen sc1
    s_add_u32 s69, s69, 4096
    buffer_load_dwordx4 v[176:179], v145, s[40:43], s69 offen sc1
    s_add_u32 s69, s69, 4096
    buffer_load_dwordx4 v[180:183], v145, s[40:43], s69 offen sc1
    s_add_u32 s69, s69, 4096
    buffer_load_dwordx4 v[184:187], v145, s[40:43], s69 offen sc1
    s_add_u32 s69, s69, 4096
    buffer_load_dwordx4 v[188:191], v145, s[40:43], s69 offen sc1
    s_add_u32 s69, s69, 4096
    buffer_load_dwordx4 v[192:195], v145, s[40:43], s69 offen sc1
    s_add_u32 s69, s69, 4096
    buffer_load_dwordx4 v[196:199], v145, s[40:43], s69 offen sc1
    s_add_u32 s69, s69, 4096
    buffer_load_dwordx4 v[200:203], v145, s[40:43], s69 offen sc1
    s_add_u32 s69, s69, 4096
    buffer_load_dwordx4 v[204:207], v145, s[40:43], s69 offen sc1
    s_add_u32 s69, s69, 4096
    buffer_load_dwordx4 v[208:211], v145, s[40:43], s69 offen sc1
    s_add_u32 s69, s69, 4096
    buffer_load_dwordx4 v[212:215], v145, s[40:43], s69 offen sc1
    s_add_u32 s69, s69, 4096
    buffer_load_dwordx4 v[216:219], v145, s[40:43], s69 offen sc1
    s_add_u32 s69, s69, 4096
    buffer_load_dwordx4 v[220:223], v145, s[40:43], s69 offen sc1
    s_add_u32 s69, s69, 4096
    buffer_load_dwordx4 v[224:227], v145, s[40:43], s69 offen sc1
    s_add_u32 s69, s69, 4096
    buffer_load_dwordx4 v[228:231], v145, s[40:43], s69 offen sc1
    s_add_u32 s69, s69, 4096
    buffer_load_dwordx4 v[232:235], v145, s[40:43], s69 offen sc1
    s_add_u32 s69, s69, 4096
    buffer_load_dwordx4 v[236:239], v145, s[40:43], s69 offen sc1
    s_add_u32 s69, s69, 4096
    s_waitcnt vmcnt(19)
    v_xor_b32 v251, s97, v161
    v_xor_b32 v252, s97, v163
    v_or3_b32 v250, v250, v251, v252
    v_add_f32 v146, v146, v160
    v_add_f32 v147, v147, v162
    buffer_load_dwordx4 v[160:163], v145, s[40:43], s69 offen sc1
    s_add_u32 s69, s69, 4096
    s_waitcnt vmcnt(19)
    v_xor_b32 v251, s97, v165
    v_xor_b32 v252, s97, v167
    v_or3_b32 v250, v250, v251, v252
    v_add_f32 v146, v146, v164
    v_add_f32 v147, v147, v166
    buffer_load_dwordx4 v[164:167], v145, s[40:43], s69 offen sc1
    s_add_u32 s69, s69, 4096
    s_waitcnt vmcnt(19)
    v_xor_b32 v251, s97, v169
    v_xor_b32 v252, s97, v171
    v_or3_b32 v250, v250, v251, v252
    v_add_f32 v146, v146, v168
    v_add_f32 v147, v147, v170
    buffer_load_dwordx4 v[168:171], v145, s[40:43], s69 offen sc1
    s_add_u32 s69, s69, 4096
    s_waitcnt vmcnt(19)
    v_xor_b32 v251, s97, v173
    v_xor_b32 v252, s97, v175
    v_or3_b32 v250, v250, v251, v252
    v_add_f32 v146, v146, v172
    v_add_f32 v147, v147, v174
    buffer_load_dwordx4 v[172:175], v145, s[40:43], s69 offen sc1
    s_add_u32 s69, s69, 4096
    s_waitcnt vmcnt(19)
    v_xor_b32 v251, s97, v177
    v_xor_b32 v252, s97, v179
    v_or3_b32 v250, v250, v251, v252
    v_add_f32 v146, v146, v176
    v_add_f32 v147, v147, v178
    buffer_load_dwordx4 v[176:179], v145, s[40:43], s69 offen sc1
    s_add_u32 s69, s69, 4096
    s_waitcnt vmcnt(19)
    v_xor_b32 v251, s97, v181
    v_xor_b32 v252, s97, v183
    v_or3_b32 v250, v250, v251, v252
    v_add_f32 v146, v146, v180
    v_add_f32 v147, v147, v182
    buffer_load_dwordx4 v[180:183], v145, s[40:43], s69 offen sc1
    s_add_u32 s69, s69, 4096
    s_waitcnt vmcnt(19)
    v_xor_b32 v251, s97, v185
    v_xor_b32 v252, s97, v187
    v_or3_b32 v250, v250, v251, v252
    v_add_f32 v146, v146, v184
    v_add_f32 v147, v147, v186
    buffer_load_dwordx4 v[184:187], v145, s[40:43], s69 offen sc1
    s_add_u32 s69, s69, 4096
    s_waitcnt vmcnt(19)
    v_xor_b32 v251, s97, v189
    v_xor_b32 v252, s97, v191
    v_or3_b32 v250, v250, v251, v252
    v_add_f32 v146, v146, v188
    v_add_f32 v147, v147, v190
    buffer_load_dwordx4 v[188:191], v145, s[40:43], s69 offen sc1
    s_add_u32 s69, s69, 4096
    s_waitcnt vmcnt(19)
    v_xor_b32 v251, s97, v193
    v_xor_b32 v252, s97, v195
    v_or3_b32 v250, v250, v251, v252
    v_add_f32 v146, v146, v192
    v_add_f32 v147, v147, v194
    buffer_load_dwordx4 v[192:195], v145, s[40:43], s69 offen sc1
    s_add_u32 s69, s69, 4096
    s_waitcnt vmcnt(19)
    v_xor_b32 v251, s97, v197
    v_xor_b32 v252, s97, v199
    v_or3_b32 v250, v250, v251, v252
    v_add_f32 v146, v146, v196
    v_add_f32 v147, v147, v198
    buffer_load_dwordx4 v[196:199], v145, s[40:43], s69 offen sc1
    s_add_u32 s69, s69, 4096
    s_waitcnt vmcnt(19)
    v_xor_b32 v251, s97, v201
    v_xor_b32 v252, s97, v203
    v_or3_b32 v250, v250, v251, v252
    v_add_f32 v146, v146, v200
    v_add_f32 v147, v147, v202
    buffer_load_dwordx4 v[200:203], v145, s[40:43], s69 offen sc1
    s_add_u32 s69, s69, 4096
    s_waitcnt vmcnt(19)
    v_xor_b32 v251, s97, v205
    v_xor_b32 v252, s97, v207
    v_or3_b32 v250, v250, v251, v252
    v_add_f32 v146, v146, v204
    v_add_f32 v147, v147, v206
    buffer_load_dwordx4 v[204:207], v145, s[40:43], s69 offen sc1
    s_add_u32 s69, s69, 4096
    s_waitcnt vmcnt(19)
    v_xor_b32 v251, s97, v209
    v_xor_b32 v252, s97, v211
    v_or3_b32 v250, v250, v251, v252
    v_add_f32 v146, v146, v208
    v_add_f32 v147, v147, v210
    s_waitcnt vmcnt(18)
    v_xor_b32 v251, s97, v213
    v_xor_b32 v252, s97, v215
    v_or3_b32 v250, v250, v251, v252
    v_add_f32 v146, v146, v212
    v_add_f32 v147, v147, v214
    s_waitcnt vmcnt(17)
    v_xor_b32 v251, s97, v217
    v_xor_b32 v252, s97, v219
    v_or3_b32 v250, v250, v251, v252
    v_add_f32 v146, v146, v216
    v_add_f32 v147, v147, v218
    s_waitcnt vmcnt(16)
    v_xor_b32 v251, s97, v221
    v_xor_b32 v252, s97, v223
    v_or3_b32 v250, v250, v251, v252
    v_add_f32 v146, v146, v220
    v_add_f32 v147, v147, v222
    s_waitcnt vmcnt(15)
    v_xor_b32 v251, s97, v225
    v_xor_b32 v252, s97, v227
    v_or3_b32 v250, v250, v251, v252
    v_add_f32 v146, v146, v224
    v_add_f32 v147, v147, v226
    s_waitcnt vmcnt(14)
    v_xor_b32 v251, s97, v229
    v_xor_b32 v252, s97, v231
    v_or3_b32 v250, v250, v251, v252
    v_add_f32 v146, v146, v228
    v_add_f32 v147, v147, v230
    s_waitcnt vmcnt(13)
    v_xor_b32 v251, s97, v233
    v_xor_b32 v252, s97, v235
    v_or3_b32 v250, v250, v251, v252
    v_add_f32 v146, v146, v232
    v_add_f32 v147, v147, v234
    s_waitcnt vmcnt(12)
    v_xor_b32 v251, s97, v237
    v_xor_b32 v252, s97, v239
    v_or3_b32 v250, v250, v251, v252
    v_add_f32 v146, v146, v236
    v_add_f32 v147, v147, v238
    s_waitcnt vmcnt(11)
    v_xor_b32 v251, s97, v161
    v_xor_b32 v252, s97, v163
    v_or3_b32 v250, v250, v251, v252
    v_add_f32 v146, v146, v160
    v_add_f32 v147, v147, v162
    s_waitcnt vmcnt(10)
    v_xor_b32 v251, s97, v165
    v_xor_b32 v252, s97, v167
    v_or3_b32 v250, v250, v251, v252
    v_add_f32 v146, v146, v164
    v_add_f32 v147, v147, v166
    s_waitcnt vmcnt(9)
    v_xor_b32 v251, s97, v169
    v_xor_b32 v252, s97, v171
    v_or3_b32 v250, v250, v251, v252
    v_add_f32 v146, v146, v168
    v_add_f32 v147, v147, v170
    s_waitcnt vmcnt(8)
    v_xor_b32 v251, s97, v173
    v_xor_b32 v252, s97, v175
    v_or3_b32 v250, v250, v251, v252
    v_add_f32 v146, v146, v172
    v_add_f32 v147, v147, v174
    s_waitcnt vmcnt(7)
    v_xor_b32 v251, s97, v177
    v_xor_b32 v252, s97, v179
    v_or3_b32 v250, v250, v251, v252
    v_add_f32 v146, v146, v176
    v_add_f32 v147, v147, v178
    s_waitcnt vmcnt(6)
    v_xor_b32 v251, s97, v181
    v_xor_b32 v252, s97, v183
    v_or3_b32 v250, v250, v251, v252
    v_add_f32 v146, v146, v180
    v_add_f32 v147, v147, v182
    s_waitcnt vmcnt(5)
    v_xor_b32 v251, s97, v185
    v_xor_b32 v252, s97, v187
    v_or3_b32 v250, v250, v251, v252
    v_add_f32 v146, v146, v184
    v_add_f32 v147, v147, v186
    s_waitcnt vmcnt(4)
    v_xor_b32 v251, s97, v189
    v_xor_b32 v252, s97, v191
    v_or3_b32 v250, v250, v251, v252
    v_add_f32 v146, v146, v188
    v_add_f32 v147, v147, v190
    s_waitcnt vmcnt(3)
    v_xor_b32 v251, s97, v193
    v_xor_b32 v252, s97, v195
    v_or3_b32 v250, v250, v251, v252
    v_add_f32 v146, v146, v192
    v_add_f32 v147, v147, v194
    s_waitcnt vmcnt(2)
    v_xor_b32 v251, s97, v197
    v_xor_b32 v252, s97, v199
    v_or3_b32 v250, v250, v251, v252
    v_add_f32 v146, v146, v196
    v_add_f32 v147, v147, v198
    s_waitcnt vmcnt(1)
    v_xor_b32 v251, s97, v201
    v_xor_b32 v252, s97, v203
    v_or3_b32 v250, v250, v251, v252
    v_add_f32 v146, v146, v200
    v_add_f32 v147, v147, v202
    s_waitcnt vmcnt(0)
    v_xor_b32 v251, s97, v205
    v_xor_b32 v252, s97, v207
    v_or3_b32 v250, v250, v251, v252
    v_add_f32 v146, v146, v204
    v_add_f32 v147, v147, v206
    v_cmp_eq_u32 vcc, 0, v250
    s_nop 4
    s_cmp_eq_u64 vcc, exec
    s_cbranch_scc1 GD4
    s_add_u32 s71, s71, 1
    s_cmp_lt_u32 s71, 0x20000
    s_cbranch_scc1 GL4
GD4:
    v_mov_b32 v192, v146
    v_mov_b32 v193, v147
    v_lshlrev_b32 v144, 3, v0
    v_cvt_pk_bf16_f32 v192, v192, v192
    v_lshlrev_b32 v192, 16, v192
    v_cvt_pk_bf16_f32 v193, v193, v193
    v_lshlrev_b32 v193, 16, v193
    v_lshlrev_b32 v146, 16, v142
    v_and_b32 v147, 0xffff0000, v142
    v_add_f32 v192, v192, v146
    v_add_f32 v193, v193, v147
    v_cvt_pk_bf16_f32 v192, v192, v192
    v_lshlrev_b32 v192, 16, v192
    v_cvt_pk_bf16_f32 v193, v193, v193
    v_lshlrev_b32 v193, 16, v193
    ds_write_b64 v144, v[192:193] offset:0
    s_waitcnt lgkmcnt(0)
    s_barrier
    v_lshlrev_b32 v144, 5, v1
    ds_read_b128 v[160:163], v144 offset:0
    ds_read_b128 v[164:167], v144 offset:16
    s_waitcnt lgkmcnt(0)
    v_add_f32 v170, v160, v161
    v_add_f32 v170, v170, v162
    v_add_f32 v170, v170, v163
    v_add_f32 v170, v170, v164
    v_add_f32 v170, v170, v165
    v_add_f32 v170, v170, v166
    v_add_f32 v170, v170, v167
    s_nop 1
    v_add_f32_dpp v170, v170, v170 quad_perm:[1,0,3,2] row_mask:0xf bank_mask:0xf
    s_nop 1
    v_add_f32_dpp v170, v170, v170 quad_perm:[2,3,0,1] row_mask:0xf bank_mask:0xf
    s_nop 1
    v_add_f32_dpp v170, v170, v170 row_half_mirror row_mask:0xf bank_mask:0xf
    s_nop 1
    v_add_f32_dpp v170, v170, v170 row_mirror row_mask:0xf bank_mask:0xf
    s_nop 1
    v_readlane_b32 s90, v170, 0
    v_readlane_b32 s91, v170, 16
    v_readlane_b32 s92, v170, 32
    v_readlane_b32 s93, v170, 48
    s_nop 1
    v_mov_b32 v170, s90
    v_add_f32 v170, s91, v170
    v_add_f32 v170, s92, v170
    v_add_f32 v170, s93, v170
    v_mul_f32 v170, 989855744, v170
    v_mov_b32 v171, 0
    v_sub_f32 v172, v160, v170
    v_fmac_f32 v171, v172, v172
    v_sub_f32 v172, v161, v170
    v_fmac_f32 v171, v172, v172
    v_sub_f32 v172, v162, v170
    v_fmac_f32 v171, v172, v172
    v_sub_f32 v172, v163, v170
    v_fmac_f32 v171, v172, v172
    v_sub_f32 v172, v164, v170
    v_fmac_f32 v171, v172, v172
    v_sub_f32 v172, v165, v170
    v_fmac_f32 v171, v172, v172
    v_sub_f32 v172, v166, v170
    v_fmac_f32 v171, v172, v172
    v_sub_f32 v172, v167, v170
    v_fmac_f32 v171, v172, v172
    s_nop 1
    v_add_f32_dpp v171, v171, v171 quad_perm:[1,0,3,2] row_mask:0xf bank_mask:0xf
    s_nop 1
    v_add_f32_dpp v171, v171, v171 quad_perm:[2,3,0,1] row_mask:0xf bank_mask:0xf
    s_nop 1
    v_add_f32_dpp v171, v171, v171 row_half_mirror row_mask:0xf bank_mask:0xf
    s_nop 1
    v_add_f32_dpp v171, v171, v171 row_mirror row_mask:0xf bank_mask:0xf
    s_nop 1
    v_readlane_b32 s90, v171, 0
    v_readlane_b32 s91, v171, 16
    v_readlane_b32 s92, v171, 32
    v_readlane_b32 s93, v171, 48
    s_nop 1
    v_mov_b32 v171, s90
    v_add_f32 v171, s91, v171
    v_add_f32 v171, s92, v171
    v_add_f32 v171, s93, v171
    v_mul_f32 v171, 989855744, v171
    v_cvt_pk_bf16_f32 v170, v170, v170
    v_lshlrev_b32 v170, 16, v170
    v_cvt_pk_bf16_f32 v171, v171, v171
    v_lshlrev_b32 v171, 16, v171
    v_add_f32 v171, 925353388, v171
    v_cvt_pk_bf16_f32 v171, v171, v171
    v_lshlrev_b32 v171, 16, v171
    v_sqrt_f32 v171, v171
    s_nop 0
    v_cvt_pk_bf16_f32 v171, v171, v171
    v_lshlrev_b32 v171, 16, v171
    v_rcp_f32 v172, v171
    s_nop 0
    v_sub_f32 v173, v160, v170
    v_cvt_pk_bf16_f32 v173, v173, v173
    v_lshlrev_b32 v173, 16, v173
    v_mul_f32 v160, v173, v172
    v_fma_f32 v174, -v160, v171, v173
    v_fma_f32 v160, v174, v172, v160
    v_cvt_pk_bf16_f32 v160, v160, v160
    v_lshlrev_b32 v160, 16, v160
    v_sub_f32 v173, v161, v170
    v_cvt_pk_bf16_f32 v173, v173, v173
    v_lshlrev_b32 v173, 16, v173
    v_mul_f32 v161, v173, v172
    v_fma_f32 v174, -v161, v171, v173
    v_fma_f32 v161, v174, v172, v161
    v_cvt_pk_bf16_f32 v161, v161, v161
    v_lshlrev_b32 v161, 16, v161
    v_sub_f32 v173, v162, v170
    v_cvt_pk_bf16_f32 v173, v173, v173
    v_lshlrev_b32 v173, 16, v173
    v_mul_f32 v162, v173, v172
    v_fma_f32 v174, -v162, v171, v173
    v_fma_f32 v162, v174, v172, v162
    v_cvt_pk_bf16_f32 v162, v162, v162
    v_lshlrev_b32 v162, 16, v162
    v_sub_f32 v173, v163, v170
    v_cvt_pk_bf16_f32 v173, v173, v173
    v_lshlrev_b32 v173, 16, v173
    v_mul_f32 v163, v173, v172
    v_fma_f32 v174, -v163, v171, v173
    v_fma_f32 v163, v174, v172, v163
    v_cvt_pk_bf16_f32 v163, v163, v163
    v_lshlrev_b32 v163, 16, v163
    v_sub_f32 v173, v164, v170
    v_cvt_pk_bf16_f32 v173, v173, v173
    v_lshlrev_b32 v173, 16, v173
    v_mul_f32 v164, v173, v172
    v_fma_f32 v174, -v164, v171, v173
    v_fma_f32 v164, v174, v172, v164
    v_cvt_pk_bf16_f32 v164, v164, v164
    v_lshlrev_b32 v164, 16, v164
    v_sub_f32 v173, v165, v170
    v_cvt_pk_bf16_f32 v173, v173, v173
    v_lshlrev_b32 v173, 16, v173
    v_mul_f32 v165, v173, v172
    v_fma_f32 v174, -v165, v171, v173
    v_fma_f32 v165, v174, v172, v165
    v_cvt_pk_bf16_f32 v165, v165, v165
    v_lshlrev_b32 v165, 16, v165
    v_sub_f32 v173, v166, v170
    v_cvt_pk_bf16_f32 v173, v173, v173
    v_lshlrev_b32 v173, 16, v173
    v_mul_f32 v166, v173, v172
    v_fma_f32 v174, -v166, v171, v173
    v_fma_f32 v166, v174, v172, v166
    v_cvt_pk_bf16_f32 v166, v166, v166
    v_lshlrev_b32 v166, 16, v166
    v_sub_f32 v173, v167, v170
    v_cvt_pk_bf16_f32 v173, v173, v173
    v_lshlrev_b32 v173, 16, v173
    v_mul_f32 v167, v173, v172
    v_fma_f32 v174, -v167, v171, v173
    v_fma_f32 v167, v174, v172, v167
    v_cvt_pk_bf16_f32 v167, v167, v167
    v_lshlrev_b32 v167, 16, v167
    ds_write_b128 v144, v[160:163] offset:4096
    ds_write_b128 v144, v[164:167] offset:4112
    s_waitcnt lgkmcnt(0)
    v_lshlrev_b32 v144, 6, v5
    ds_read_b128 v[192:195], v144 offset:4096
    ds_read_b128 v[196:199], v144 offset:4112
    ds_read_b128 v[200:203], v144 offset:4128
    ds_read_b128 v[204:207], v144 offset:4144
    v_mov_b32 v160, 0
    v_mov_b32 v161, 0
    v_mov_b32 v162, 0
    v_mov_b32 v163, 0
    v_mov_b32 v164, 0
    v_mov_b32 v165, 0
    v_mov_b32 v166, 0
    v_mov_b32 v167, 0
    s_waitcnt lgkmcnt(0)
    v_lshlrev_b32 v168, 16, v8
    v_and_b32 v169, 0xffff0000, v8
    v_lshlrev_b32 v170, 16, v9
    v_and_b32 v171, 0xffff0000, v9
    v_lshlrev_b32 v172, 16, v10
    v_and_b32 v173, 0xffff0000, v10
    v_lshlrev_b32 v174, 16, v11
    v_and_b32 v175, 0xffff0000, v11
    v_pk_fma_f32 v[160:161], v[192:193], v[168:169], v[160:161] op_sel_hi:[0,1,1]
    v_pk_fma_f32 v[162:163], v[192:193], v[170:171], v[162:163] op_sel_hi:[0,1,1]
    v_pk_fma_f32 v[164:165], v[192:193], v[172:173], v[164:165] op_sel_hi:[0,1,1]
    v_pk_fma_f32 v[166:167], v[192:193], v[174:175], v[166:167] op_sel_hi:[0,1,1]
    v_lshlrev_b32 v168, 16, v12
    v_and_b32 v169, 0xffff0000, v12
    v_lshlrev_b32 v170, 16, v13
    v_and_b32 v171, 0xffff0000, v13
    v_lshlrev_b32 v172, 16, v14
    v_and_b32 v173, 0xffff0000, v14
    v_lshlrev_b32 v174, 16, v15
    v_and_b32 v175, 0xffff0000, v15
    v_pk_fma_f32 v[160:161], v[192:193], v[168:169], v[160:161] op_sel:[1,0,0] op_sel_hi:[1,1,1]
    v_pk_fma_f32 v[162:163], v[192:193], v[170:171], v[162:163] op_sel:[1,0,0] op_sel_hi:[1,1,1]
    v_pk_fma_f32 v[164:165], v[192:193], v[172:173], v[164:165] op_sel:[1,0,0] op_sel_hi:[1,1,1]
    v_pk_fma_f32 v[166:167], v[192:193], v[174:175], v[166:167] op_sel:[1,0,0] op_sel_hi:[1,1,1]
    v_lshlrev_b32 v168, 16, v16
    v_and_b32 v169, 0xffff0000, v16
    v_lshlrev_b32 v170, 16, v17
    v_and_b32 v171, 0xffff0000, v17
    v_lshlrev_b32 v172, 16, v18
    v_and_b32 v173, 0xffff0000, v18
    v_lshlrev_b32 v174, 16, v19
    v_and_b32 v175, 0xffff0000, v19
    v_pk_fma_f32 v[160:161], v[194:195], v[168:169], v[160:161] op_sel_hi:[0,1,1]
    v_pk_fma_f32 v[162:163], v[194:195], v[170:171], v[162:163] op_sel_hi:[0,1,1]
    v_pk_fma_f32 v[164:165], v[194:195], v[172:173], v[164:165] op_sel_hi:[0,1,1]
    v_pk_fma_f32 v[166:167], v[194:195], v[174:175], v[166:167] op_sel_hi:[0,1,1]
    v_lshlrev_b32 v168, 16, v20
    v_and_b32 v169, 0xffff0000, v20
    v_lshlrev_b32 v170, 16, v21
    v_and_b32 v171, 0xffff0000, v21
    v_lshlrev_b32 v172, 16, v22
    v_and_b32 v173, 0xffff0000, v22
    v_lshlrev_b32 v174, 16, v23
    v_and_b32 v175, 0xffff0000, v23
    v_pk_fma_f32 v[160:161], v[194:195], v[168:169], v[160:161] op_sel:[1,0,0] op_sel_hi:[1,1,1]
    v_pk_fma_f32 v[162:163], v[194:195], v[170:171], v[162:163] op_sel:[1,0,0] op_sel_hi:[1,1,1]
    v_pk_fma_f32 v[164:165], v[194:195], v[172:173], v[164:165] op_sel:[1,0,0] op_sel_hi:[1,1,1]
    v_pk_fma_f32 v[166:167], v[194:195], v[174:175], v[166:167] op_sel:[1,0,0] op_sel_hi:[1,1,1]
    v_lshlrev_b32 v168, 16, v24
    v_and_b32 v169, 0xffff0000, v24
    v_lshlrev_b32 v170, 16, v25
    v_and_b32 v171, 0xffff0000, v25
    v_lshlrev_b32 v172, 16, v26
    v_and_b32 v173, 0xffff0000, v26
    v_lshlrev_b32 v174, 16, v27
    v_and_b32 v175, 0xffff0000, v27
    v_pk_fma_f32 v[160:161], v[196:197], v[168:169], v[160:161] op_sel_hi:[0,1,1]
    v_pk_fma_f32 v[162:163], v[196:197], v[170:171], v[162:163] op_sel_hi:[0,1,1]
    v_pk_fma_f32 v[164:165], v[196:197], v[172:173], v[164:165] op_sel_hi:[0,1,1]
    v_pk_fma_f32 v[166:167], v[196:197], v[174:175], v[166:167] op_sel_hi:[0,1,1]
    v_lshlrev_b32 v168, 16, v28
    v_and_b32 v169, 0xffff0000, v28
    v_lshlrev_b32 v170, 16, v29
    v_and_b32 v171, 0xffff0000, v29
    v_lshlrev_b32 v172, 16, v30
    v_and_b32 v173, 0xffff0000, v30
    v_lshlrev_b32 v174, 16, v31
    v_and_b32 v175, 0xffff0000, v31
    v_pk_fma_f32 v[160:161], v[196:197], v[168:169], v[160:161] op_sel:[1,0,0] op_sel_hi:[1,1,1]
    v_pk_fma_f32 v[162:163], v[196:197], v[170:171], v[162:163] op_sel:[1,0,0] op_sel_hi:[1,1,1]
    v_pk_fma_f32 v[164:165], v[196:197], v[172:173], v[164:165] op_sel:[1,0,0] op_sel_hi:[1,1,1]
    v_pk_fma_f32 v[166:167], v[196:197], v[174:175], v[166:167] op_sel:[1,0,0] op_sel_hi:[1,1,1]
    v_lshlrev_b32 v168, 16, v32
    v_and_b32 v169, 0xffff0000, v32
    v_lshlrev_b32 v170, 16, v33
    v_and_b32 v171, 0xffff0000, v33
    v_lshlrev_b32 v172, 16, v34
    v_and_b32 v173, 0xffff0000, v34
    v_lshlrev_b32 v174, 16, v35
    v_and_b32 v175, 0xffff0000, v35
    v_pk_fma_f32 v[160:161], v[198:199], v[168:169], v[160:161] op_sel_hi:[0,1,1]
    v_pk_fma_f32 v[162:163], v[198:199], v[170:171], v[162:163] op_sel_hi:[0,1,1]
    v_pk_fma_f32 v[164:165], v[198:199], v[172:173], v[164:165] op_sel_hi:[0,1,1]
    v_pk_fma_f32 v[166:167], v[198:199], v[174:175], v[166:167] op_sel_hi:[0,1,1]
    v_lshlrev_b32 v168, 16, v36
    v_and_b32 v169, 0xffff0000, v36
    v_lshlrev_b32 v170, 16, v37
    v_and_b32 v171, 0xffff0000, v37
    v_lshlrev_b32 v172, 16, v38
    v_and_b32 v173, 0xffff0000, v38
    v_lshlrev_b32 v174, 16, v39
    v_and_b32 v175, 0xffff0000, v39
    v_pk_fma_f32 v[160:161], v[198:199], v[168:169], v[160:161] op_sel:[1,0,0] op_sel_hi:[1,1,1]
    v_pk_fma_f32 v[162:163], v[198:199], v[170:171], v[162:163] op_sel:[1,0,0] op_sel_hi:[1,1,1]
    v_pk_fma_f32 v[164:165], v[198:199], v[172:173], v[164:165] op_sel:[1,0,0] op_sel_hi:[1,1,1]
    v_pk_fma_f32 v[166:167], v[198:199], v[174:175], v[166:167] op_sel:[1,0,0] op_sel_hi:[1,1,1]
    v_lshlrev_b32 v168, 16, v40
    v_and_b32 v169, 0xffff0000, v40
    v_lshlrev_b32 v170, 16, v41
    v_and_b32 v171, 0xffff0000, v41
    v_lshlrev_b32 v172, 16, v42
    v_and_b32 v173, 0xffff0000, v42
    v_lshlrev_b32 v174, 16, v43
    v_and_b32 v175, 0xffff0000, v43
    v_pk_fma_f32 v[160:161], v[200:201], v[168:169], v[160:161] op_sel_hi:[0,1,1]
    v_pk_fma_f32 v[162:163], v[200:201], v[170:171], v[162:163] op_sel_hi:[0,1,1]
    v_pk_fma_f32 v[164:165], v[200:201], v[172:173], v[164:165] op_sel_hi:[0,1,1]
    v_pk_fma_f32 v[166:167], v[200:201], v[174:175], v[166:167] op_sel_hi:[0,1,1]
    v_lshlrev_b32 v168, 16, v44
    v_and_b32 v169, 0xffff0000, v44
    v_lshlrev_b32 v170, 16, v45
    v_and_b32 v171, 0xffff0000, v45
    v_lshlrev_b32 v172, 16, v46
    v_and_b32 v173, 0xffff0000, v46
    v_lshlrev_b32 v174, 16, v47
    v_and_b32 v175, 0xffff0000, v47
    v_pk_fma_f32 v[160:161], v[200:201], v[168:169], v[160:161] op_sel:[1,0,0] op_sel_hi:[1,1,1]
    v_pk_fma_f32 v[162:163], v[200:201], v[170:171], v[162:163] op_sel:[1,0,0] op_sel_hi:[1,1,1]
    v_pk_fma_f32 v[164:165], v[200:201], v[172:173], v[164:165] op_sel:[1,0,0] op_sel_hi:[1,1,1]
    v_pk_fma_f32 v[166:167], v[200:201], v[174:175], v[166:167] op_sel:[1,0,0] op_sel_hi:[1,1,1]
    v_lshlrev_b32 v168, 16, v48
    v_and_b32 v169, 0xffff0000, v48
    v_lshlrev_b32 v170, 16, v49
    v_and_b32 v171, 0xffff0000, v49
    v_lshlrev_b32 v172, 16, v50
    v_and_b32 v173, 0xffff0000, v50
    v_lshlrev_b32 v174, 16, v51
    v_and_b32 v175, 0xffff0000, v51
    v_pk_fma_f32 v[160:161], v[202:203], v[168:169], v[160:161] op_sel_hi:[0,1,1]
    v_pk_fma_f32 v[162:163], v[202:203], v[170:171], v[162:163] op_sel_hi:[0,1,1]
    v_pk_fma_f32 v[164:165], v[202:203], v[172:173], v[164:165] op_sel_hi:[0,1,1]
    v_pk_fma_f32 v[166:167], v[202:203], v[174:175], v[166:167] op_sel_hi:[0,1,1]
    v_lshlrev_b32 v168, 16, v52
    v_and_b32 v169, 0xffff0000, v52
    v_lshlrev_b32 v170, 16, v53
    v_and_b32 v171, 0xffff0000, v53
    v_lshlrev_b32 v172, 16, v54
    v_and_b32 v173, 0xffff0000, v54
    v_lshlrev_b32 v174, 16, v55
    v_and_b32 v175, 0xffff0000, v55
    v_pk_fma_f32 v[160:161], v[202:203], v[168:169], v[160:161] op_sel:[1,0,0] op_sel_hi:[1,1,1]
    v_pk_fma_f32 v[162:163], v[202:203], v[170:171], v[162:163] op_sel:[1,0,0] op_sel_hi:[1,1,1]
    v_pk_fma_f32 v[164:165], v[202:203], v[172:173], v[164:165] op_sel:[1,0,0] op_sel_hi:[1,1,1]
    v_pk_fma_f32 v[166:167], v[202:203], v[174:175], v[166:167] op_sel:[1,0,0] op_sel_hi:[1,1,1]
    v_lshlrev_b32 v168, 16, v56
    v_and_b32 v169, 0xffff0000, v56
    v_lshlrev_b32 v170, 16, v57
    v_and_b32 v171, 0xffff0000, v57
    v_lshlrev_b32 v172, 16, v58
    v_and_b32 v173, 0xffff0000, v58
    v_lshlrev_b32 v174, 16, v59
    v_and_b32 v175, 0xffff0000, v59
    v_pk_fma_f32 v[160:161], v[204:205], v[168:169], v[160:161] op_sel_hi:[0,1,1]
    v_pk_fma_f32 v[162:163], v[204:205], v[170:171], v[162:163] op_sel_hi:[0,1,1]
    v_pk_fma_f32 v[164:165], v[204:205], v[172:173], v[164:165] op_sel_hi:[0,1,1]
    v_pk_fma_f32 v[166:167], v[204:205], v[174:175], v[166:167] op_sel_hi:[0,1,1]
    v_lshlrev_b32 v168, 16, v60
    v_and_b32 v169, 0xffff0000, v60
    v_lshlrev_b32 v170, 16, v61
    v_and_b32 v171, 0xffff0000, v61
    v_lshlrev_b32 v172, 16, v62
    v_and_b32 v173, 0xffff0000, v62
    v_lshlrev_b32 v174, 16, v63
    v_and_b32 v175, 0xffff0000, v63
    v_pk_fma_f32 v[160:161], v[204:205], v[168:169], v[160:161] op_sel:[1,0,0] op_sel_hi:[1,1,1]
    v_pk_fma_f32 v[162:163], v[204:205], v[170:171], v[162:163] op_sel:[1,0,0] op_sel_hi:[1,1,1]
    v_pk_fma_f32 v[164:165], v[204:205], v[172:173], v[164:165] op_sel:[1,0,0] op_sel_hi:[1,1,1]
    v_pk_fma_f32 v[166:167], v[204:205], v[174:175], v[166:167] op_sel:[1,0,0] op_sel_hi:[1,1,1]
    v_lshlrev_b32 v168, 16, v64
    v_and_b32 v169, 0xffff0000, v64
    v_lshlrev_b32 v170, 16, v65
    v_and_b32 v171, 0xffff0000, v65
    v_lshlrev_b32 v172, 16, v66
    v_and_b32 v173, 0xffff0000, v66
    v_lshlrev_b32 v174, 16, v67
    v_and_b32 v175, 0xffff0000, v67
    v_pk_fma_f32 v[160:161], v[206:207], v[168:169], v[160:161] op_sel_hi:[0,1,1]
    v_pk_fma_f32 v[162:163], v[206:207], v[170:171], v[162:163] op_sel_hi:[0,1,1]
    v_pk_fma_f32 v[164:165], v[206:207], v[172:173], v[164:165] op_sel_hi:[0,1,1]
    v_pk_fma_f32 v[166:167], v[206:207], v[174:175], v[166:167] op_sel_hi:[0,1,1]
    v_lshlrev_b32 v168, 16, v68
    v_and_b32 v169, 0xffff0000, v68
    v_lshlrev_b32 v170, 16, v69
    v_and_b32 v171, 0xffff0000, v69
    v_lshlrev_b32 v172, 16, v70
    v_and_b32 v173, 0xffff0000, v70
    v_lshlrev_b32 v174, 16, v71
    v_and_b32 v175, 0xffff0000, v71
    v_pk_fma_f32 v[160:161], v[206:207], v[168:169], v[160:161] op_sel:[1,0,0] op_sel_hi:[1,1,1]
    v_pk_fma_f32 v[162:163], v[206:207], v[170:171], v[162:163] op_sel:[1,0,0] op_sel_hi:[1,1,1]
    v_pk_fma_f32 v[164:165], v[206:207], v[172:173], v[164:165] op_sel:[1,0,0] op_sel_hi:[1,1,1]
    v_pk_fma_f32 v[166:167], v[206:207], v[174:175], v[166:167] op_sel:[1,0,0] op_sel_hi:[1,1,1]
    v_lshlrev_b32 v144, 8, v5
    v_lshl_add_u32 v144, v6, 5, v144
    ds_write_b128 v144, v[160:163] offset:8192
    ds_write_b128 v144, v[164:167] offset:8208
    s_waitcnt lgkmcnt(0)
    s_barrier
    v_lshlrev_b32 v144, 2, v1
    ds_read_b32 v192, v144 offset:8192
    ds_read_b32 v193, v144 offset:8448
    ds_read_b32 v194, v144 offset:8704
    ds_read_b32 v195, v144 offset:8960
    ds_read_b32 v196, v144 offset:9216
    ds_read_b32 v197, v144 offset:9472
    ds_read_b32 v198, v144 offset:9728
    ds_read_b32 v199, v144 offset:9984
    ds_read_b32 v200, v144 offset:10240
    ds_read_b32 v201, v144 offset:10496
    ds_read_b32 v202, v144 offset:10752
    ds_read_b32 v203, v144 offset:11008
    ds_read_b32 v204, v144 offset:11264
    ds_read_b32 v205, v144 offset:11520
    ds_read_b32 v206, v144 offset:11776
    ds_read_b32 v207, v144 offset:12032
    ds_read_b32 v208, v144 offset:12288
    ds_read_b32 v209, v144 offset:12544
    ds_read_b32 v210, v144 offset:12800
    ds_read_b32 v211, v144 offset:13056
    ds_read_b32 v212, v144 offset:13312
    ds_read_b32 v213, v144 offset:13568
    ds_read_b32 v214, v144 offset:13824
    ds_read_b32 v215, v144 offset:14080
    ds_read_b32 v216, v144 offset:14336
    ds_read_b32 v217, v144 offset:14592
    ds_read_b32 v218, v144 offset:14848
    ds_read_b32 v219, v144 offset:15104
    ds_read_b32 v220, v144 offset:15360
    ds_read_b32 v221, v144 offset:15616
    ds_read_b32 v222, v144 offset:15872
    ds_read_b32 v223, v144 offset:16128
    s_lshl_b32 s63, s60, 4
    v_mov_b32 v160, 0
    v_mov_b32 v161, 0
    v_mov_b32 v162, 0
    v_mov_b32 v163, 0
    v_mov_b32 v164, 0
    v_mov_b32 v165, 0
    v_mov_b32 v166, 0
    v_mov_b32 v167, 0
    s_waitcnt lgkmcnt(0)
    v_add_f32 v192, v192, v193
    v_add_f32 v192, v192, v194
    v_add_f32 v192, v192, v195
    v_add_f32 v192, v192, v196
    v_add_f32 v192, v192, v197
    v_add_f32 v192, v192, v198
    v_add_f32 v192, v192, v199
    v_add_f32 v192, v192, v200
    v_add_f32 v192, v192, v201
    v_add_f32 v192, v192, v202
    v_add_f32 v192, v192, v203
    v_add_f32 v192, v192, v204
    v_add_f32 v192, v192, v205
    v_add_f32 v192, v192, v206
    v_add_f32 v192, v192, v207
    v_add_f32 v192, v192, v208
    v_add_f32 v192, v192, v209
    v_add_f32 v192, v192, v210
    v_add_f32 v192, v192, v211
    v_add_f32 v192, v192, v212
    v_add_f32 v192, v192, v213
    v_add_f32 v192, v192, v214
    v_add_f32 v192, v192, v215
    v_add_f32 v192, v192, v216
    v_add_f32 v192, v192, v217
    v_add_f32 v192, v192, v218
    v_add_f32 v192, v192, v219
    v_add_f32 v192, v192, v220
    v_add_f32 v192, v192, v221
    v_add_f32 v192, v192, v222
    v_add_f32 v192, v192, v223
    v_mov_b32 v176, v192
    v_cvt_pk_bf16_f32 v176, v176, v176
    v_lshlrev_b32 v176, 16, v176
    v_lshlrev_b32 v140, 16, v140
    v_add_f32 v176, v176, v140
    v_cvt_pk_bf16_f32 v176, v176, v176
    v_lshlrev_b32 v176, 16, v176
    v_mul_f32 v177, v176, v176
    v_mul_f32 v177, v177, v176
    s_mov_b32 s69, 0x3d372713
    v_fma_f32 v177, v177, s69, v176
    v_mul_f32 v177, 0x40135761, v177
    v_exp_f32 v177, v177
    s_nop 0
    v_add_f32 v177, 1.0, v177
    v_rcp_f32 v177, v177
    s_nop 0
    v_fma_f32 v177, v177, -2.0, 1.0
    v_add_f32 v177, 1.0, v177
    v_mul_f32 v177, v177, v176
    v_mul_f32 v177, 0.5, v177
    v_cvt_pk_bf16_f32 v177, v177, v177
    v_lshlrev_b32 v177, 16, v177
    s_nop 1
    v_readlane_b32 s64, v177, s63
    s_add_u32 s63, s63, 1
    v_readlane_b32 s65, v177, s63
    s_add_u32 s63, s63, 1
    v_readlane_b32 s66, v177, s63
    s_add_u32 s63, s63, 1
    v_readlane_b32 s67, v177, s63
    s_add_u32 s63, s63, 1
    v_readlane_b32 s68, v177, s63
    s_add_u32 s63, s63, 1
    v_readlane_b32 s69, v177, s63
    s_add_u32 s63, s63, 1
    v_readlane_b32 s70, v177, s63
    s_add_u32 s63, s63, 1
    v_readlane_b32 s71, v177, s63
    s_add_u32 s63, s63, 1
    v_readlane_b32 s72, v177, s63
    s_add_u32 s63, s63, 1
    v_readlane_b32 s73, v177, s63
    s_add_u32 s63, s63, 1
    v_readlane_b32 s74, v177, s63
    s_add_u32 s63, s63, 1
    v_readlane_b32 s75, v177, s63
    s_add_u32 s63, s63, 1
    v_readlane_b32 s76, v177, s63
    s_add_u32 s63, s63, 1
    v_readlane_b32 s77, v177, s63
    s_add_u32 s63, s63, 1
    v_readlane_b32 s78, v177, s63
    s_add_u32 s63, s63, 1
    v_readlane_b32 s79, v177, s63
    s_nop 1
    v_lshlrev_b32 v168, 16, v72
    v_and_b32 v169, 0xffff0000, v72
    v_lshlrev_b32 v170, 16, v73
    v_and_b32 v171, 0xffff0000, v73
    v_lshlrev_b32 v172, 16, v74
    v_and_b32 v173, 0xffff0000, v74
    v_lshlrev_b32 v174, 16, v75
    v_and_b32 v175, 0xffff0000, v75
    v_pk_fma_f32 v[160:161], s[64:65], v[168:169], v[160:161] op_sel_hi:[0,1,1]
    v_pk_fma_f32 v[162:163], s[64:65], v[170:171], v[162:163] op_sel_hi:[0,1,1]
    v_pk_fma_f32 v[164:165], s[64:65], v[172:173], v[164:165] op_sel_hi:[0,1,1]
    v_pk_fma_f32 v[166:167], s[64:65], v[174:175], v[166:167] op_sel_hi:[0,1,1]
    v_lshlrev_b32 v168, 16, v76
    v_and_b32 v169, 0xffff0000, v76
    v_lshlrev_b32 v170, 16, v77
    v_and_b32 v171, 0xffff0000, v77
    v_lshlrev_b32 v172, 16, v78
    v_and_b32 v173, 0xffff0000, v78
    v_lshlrev_b32 v174, 16, v79
    v_and_b32 v175, 0xffff0000, v79
    v_pk_fma_f32 v[160:161], s[64:65], v[168:169], v[160:161] op_sel:[1,0,0] op_sel_hi:[1,1,1]
    v_pk_fma_f32 v[162:163], s[64:65], v[170:171], v[162:163] op_sel:[1,0,0] op_sel_hi:[1,1,1]
    v_pk_fma_f32 v[164:165], s[64:65], v[172:173], v[164:165] op_sel:[1,0,0] op_sel_hi:[1,1,1]
    v_pk_fma_f32 v[166:167], s[64:65], v[174:175], v[166:167] op_sel:[1,0,0] op_sel_hi:[1,1,1]
    v_lshlrev_b32 v168, 16, v80
    v_and_b32 v169, 0xffff0000, v80
    v_lshlrev_b32 v170, 16, v81
    v_and_b32 v171, 0xffff0000, v81
    v_lshlrev_b32 v172, 16, v82
    v_and_b32 v173, 0xffff0000, v82
    v_lshlrev_b32 v174, 16, v83
    v_and_b32 v175, 0xffff0000, v83
    v_pk_fma_f32 v[160:161], s[66:67], v[168:169], v[160:161] op_sel_hi:[0,1,1]
    v_pk_fma_f32 v[162:163], s[66:67], v[170:171], v[162:163] op_sel_hi:[0,1,1]
    v_pk_fma_f32 v[164:165], s[66:67], v[172:173], v[164:165] op_sel_hi:[0,1,1]
    v_pk_fma_f32 v[166:167], s[66:67], v[174:175], v[166:167] op_sel_hi:[0,1,1]
    v_lshlrev_b32 v168, 16, v84
    v_and_b32 v169, 0xffff0000, v84
    v_lshlrev_b32 v170, 16, v85
    v_and_b32 v171, 0xffff0000, v85
    v_lshlrev_b32 v172, 16, v86
    v_and_b32 v173, 0xffff0000, v86
    v_lshlrev_b32 v174, 16, v87
    v_and_b32 v175, 0xffff0000, v87
    v_pk_fma_f32 v[160:161], s[66:67], v[168:169], v[160:161] op_sel:[1,0,0] op_sel_hi:[1,1,1]
    v_pk_fma_f32 v[162:163], s[66:67], v[170:171], v[162:163] op_sel:[1,0,0] op_sel_hi:[1,1,1]
    v_pk_fma_f32 v[164:165], s[66:67], v[172:173], v[164:165] op_sel:[1,0,0] op_sel_hi:[1,1,1]
    v_pk_fma_f32 v[166:167], s[66:67], v[174:175], v[166:167] op_sel:[1,0,0] op_sel_hi:[1,1,1]
    v_lshlrev_b32 v168, 16, v88
    v_and_b32 v169, 0xffff0000, v88
    v_lshlrev_b32 v170, 16, v89
    v_and_b32 v171, 0xffff0000, v89
    v_lshlrev_b32 v172, 16, v90
    v_and_b32 v173, 0xffff0000, v90
    v_lshlrev_b32 v174, 16, v91
    v_and_b32 v175, 0xffff0000, v91
    v_pk_fma_f32 v[160:161], s[68:69], v[168:169], v[160:161] op_sel_hi:[0,1,1]
    v_pk_fma_f32 v[162:163], s[68:69], v[170:171], v[162:163] op_sel_hi:[0,1,1]
    v_pk_fma_f32 v[164:165], s[68:69], v[172:173], v[164:165] op_sel_hi:[0,1,1]
    v_pk_fma_f32 v[166:167], s[68:69], v[174:175], v[166:167] op_sel_hi:[0,1,1]
    v_lshlrev_b32 v168, 16, v92
    v_and_b32 v169, 0xffff0000, v92
    v_lshlrev_b32 v170, 16, v93
    v_and_b32 v171, 0xffff0000, v93
    v_lshlrev_b32 v172, 16, v94
    v_and_b32 v173, 0xffff0000, v94
    v_lshlrev_b32 v174, 16, v95
    v_and_b32 v175, 0xffff0000, v95
    v_pk_fma_f32 v[160:161], s[68:69], v[168:169], v[160:161] op_sel:[1,0,0] op_sel_hi:[1,1,1]
    v_pk_fma_f32 v[162:163], s[68:69], v[170:171], v[162:163] op_sel:[1,0,0] op_sel_hi:[1,1,1]
    v_pk_fma_f32 v[164:165], s[68:69], v[172:173], v[164:165] op_sel:[1,0,0] op_sel_hi:[1,1,1]
    v_pk_fma_f32 v[166:167], s[68:69], v[174:175], v[166:167] op_sel:[1,0,0] op_sel_hi:[1,1,1]
    v_lshlrev_b32 v168, 16, v96
    v_and_b32 v169, 0xffff0000, v96
    v_lshlrev_b32 v170, 16, v97
    v_and_b32 v171, 0xffff0000, v97
    v_lshlrev_b32 v172, 16, v98
    v_and_b32 v173, 0xffff0000, v98
    v_lshlrev_b32 v174, 16, v99
    v_and_b32 v175, 0xffff0000, v99
    v_pk_fma_f32 v[160:161], s[70:71], v[168:169], v[160:161] op_sel_hi:[0,1,1]
    v_pk_fma_f32 v[162:163], s[70:71], v[170:171], v[162:163] op_sel_hi:[0,1,1]
    v_pk_fma_f32 v[164:165], s[70:71], v[172:173], v[164:165] op_sel_hi:[0,1,1]
    v_pk_fma_f32 v[166:167], s[70:71], v[174:175], v[166:167] op_sel_hi:[0,1,1]
    v_lshlrev_b32 v168, 16, v100
    v_and_b32 v169, 0xffff0000, v100
    v_lshlrev_b32 v170, 16, v101
    v_and_b32 v171, 0xffff0000, v101
    v_lshlrev_b32 v172, 16, v102
    v_and_b32 v173, 0xffff0000, v102
    v_lshlrev_b32 v174, 16, v103
    v_and_b32 v175, 0xffff0000, v103
    v_pk_fma_f32 v[160:161], s[70:71], v[168:169], v[160:161] op_sel:[1,0,0] op_sel_hi:[1,1,1]
    v_pk_fma_f32 v[162:163], s[70:71], v[170:171], v[162:163] op_sel:[1,0,0] op_sel_hi:[1,1,1]
    v_pk_fma_f32 v[164:165], s[70:71], v[172:173], v[164:165] op_sel:[1,0,0] op_sel_hi:[1,1,1]
    v_pk_fma_f32 v[166:167], s[70:71], v[174:175], v[166:167] op_sel:[1,0,0] op_sel_hi:[1,1,1]
    v_lshlrev_b32 v168, 16, v104
    v_and_b32 v169, 0xffff0000, v104
    v_lshlrev_b32 v170, 16, v105
    v_and_b32 v171, 0xffff0000, v105
    v_lshlrev_b32 v172, 16, v106
    v_and_b32 v173, 0xffff0000, v106
    v_lshlrev_b32 v174, 16, v107
    v_and_b32 v175, 0xffff0000, v107
    v_pk_fma_f32 v[160:161], s[72:73], v[168:169], v[160:161] op_sel_hi:[0,1,1]
    v_pk_fma_f32 v[162:163], s[72:73], v[170:171], v[162:163] op_sel_hi:[0,1,1]
    v_pk_fma_f32 v[164:165], s[72:73], v[172:173], v[164:165] op_sel_hi:[0,1,1]
    v_pk_fma_f32 v[166:167], s[72:73], v[174:175], v[166:167] op_sel_hi:[0,1,1]
    v_lshlrev_b32 v168, 16, v108
    v_and_b32 v169, 0xffff0000, v108
    v_lshlrev_b32 v170, 16, v109
    v_and_b32 v171, 0xffff0000, v109
    v_lshlrev_b32 v172, 16, v110
    v_and_b32 v173, 0xffff0000, v110
    v_lshlrev_b32 v174, 16, v111
    v_and_b32 v175, 0xffff0000, v111
    v_pk_fma_f32 v[160:161], s[72:73], v[168:169], v[160:161] op_sel:[1,0,0] op_sel_hi:[1,1,1]
    v_pk_fma_f32 v[162:163], s[72:73], v[170:171], v[162:163] op_sel:[1,0,0] op_sel_hi:[1,1,1]
    v_pk_fma_f32 v[164:165], s[72:73], v[172:173], v[164:165] op_sel:[1,0,0] op_sel_hi:[1,1,1]
    v_pk_fma_f32 v[166:167], s[72:73], v[174:175], v[166:167] op_sel:[1,0,0] op_sel_hi:[1,1,1]
    v_lshlrev_b32 v168, 16, v112
    v_and_b32 v169, 0xffff0000, v112
    v_lshlrev_b32 v170, 16, v113
    v_and_b32 v171, 0xffff0000, v113
    v_lshlrev_b32 v172, 16, v114
    v_and_b32 v173, 0xffff0000, v114
    v_lshlrev_b32 v174, 16, v115
    v_and_b32 v175, 0xffff0000, v115
    v_pk_fma_f32 v[160:161], s[74:75], v[168:169], v[160:161] op_sel_hi:[0,1,1]
    v_pk_fma_f32 v[162:163], s[74:75], v[170:171], v[162:163] op_sel_hi:[0,1,1]
    v_pk_fma_f32 v[164:165], s[74:75], v[172:173], v[164:165] op_sel_hi:[0,1,1]
    v_pk_fma_f32 v[166:167], s[74:75], v[174:175], v[166:167] op_sel_hi:[0,1,1]
    v_lshlrev_b32 v168, 16, v116
    v_and_b32 v169, 0xffff0000, v116
    v_lshlrev_b32 v170, 16, v117
    v_and_b32 v171, 0xffff0000, v117
    v_lshlrev_b32 v172, 16, v118
    v_and_b32 v173, 0xffff0000, v118
    v_lshlrev_b32 v174, 16, v119
    v_and_b32 v175, 0xffff0000, v119
    v_pk_fma_f32 v[160:161], s[74:75], v[168:169], v[160:161] op_sel:[1,0,0] op_sel_hi:[1,1,1]
    v_pk_fma_f32 v[162:163], s[74:75], v[170:171], v[162:163] op_sel:[1,0,0] op_sel_hi:[1,1,1]
    v_pk_fma_f32 v[164:165], s[74:75], v[172:173], v[164:165] op_sel:[1,0,0] op_sel_hi:[1,1,1]
    v_pk_fma_f32 v[166:167], s[74:75], v[174:175], v[166:167] op_sel:[1,0,0] op_sel_hi:[1,1,1]
    v_lshlrev_b32 v168, 16, v120
    v_and_b32 v169, 0xffff0000, v120
    v_lshlrev_b32 v170, 16, v121
    v_and_b32 v171, 0xffff0000, v121
    v_lshlrev_b32 v172, 16, v122
    v_and_b32 v173, 0xffff0000, v122
    v_lshlrev_b32 v174, 16, v123
    v_and_b32 v175, 0xffff0000, v123
    v_pk_fma_f32 v[160:161], s[76:77], v[168:169], v[160:161] op_sel_hi:[0,1,1]
    v_pk_fma_f32 v[162:163], s[76:77], v[170:171], v[162:163] op_sel_hi:[0,1,1]
    v_pk_fma_f32 v[164:165], s[76:77], v[172:173], v[164:165] op_sel_hi:[0,1,1]
    v_pk_fma_f32 v[166:167], s[76:77], v[174:175], v[166:167] op_sel_hi:[0,1,1]
    v_lshlrev_b32 v168, 16, v124
    v_and_b32 v169, 0xffff0000, v124
    v_lshlrev_b32 v170, 16, v125
    v_and_b32 v171, 0xffff0000, v125
    v_lshlrev_b32 v172, 16, v126
    v_and_b32 v173, 0xffff0000, v126
    v_lshlrev_b32 v174, 16, v127
    v_and_b32 v175, 0xffff0000, v127
    v_pk_fma_f32 v[160:161], s[76:77], v[168:169], v[160:161] op_sel:[1,0,0] op_sel_hi:[1,1,1]
    v_pk_fma_f32 v[162:163], s[76:77], v[170:171], v[162:163] op_sel:[1,0,0] op_sel_hi:[1,1,1]
    v_pk_fma_f32 v[164:165], s[76:77], v[172:173], v[164:165] op_sel:[1,0,0] op_sel_hi:[1,1,1]
    v_pk_fma_f32 v[166:167], s[76:77], v[174:175], v[166:167] op_sel:[1,0,0] op_sel_hi:[1,1,1]
    v_lshlrev_b32 v168, 16, v128
    v_and_b32 v169, 0xffff0000, v128
    v_lshlrev_b32 v170, 16, v129
    v_and_b32 v171, 0xffff0000, v129
    v_lshlrev_b32 v172, 16, v130
    v_and_b32 v173, 0xffff0000, v130
    v_lshlrev_b32 v174, 16, v131
    v_and_b32 v175, 0xffff0000, v131
    v_pk_fma_f32 v[160:161], s[78:79], v[168:169], v[160:161] op_sel_hi:[0,1,1]
    v_pk_fma_f32 v[162:163], s[78:79], v[170:171], v[162:163] op_sel_hi:[0,1,1]
    v_pk_fma_f32 v[164:165], s[78:79], v[172:173], v[164:165] op_sel_hi:[0,1,1]
    v_pk_fma_f32 v[166:167], s[78:79], v[174:175], v[166:167] op_sel_hi:[0,1,1]
    v_lshlrev_b32 v168, 16, v132
    v_and_b32 v169, 0xffff0000, v132
    v_lshlrev_b32 v170, 16, v133
    v_and_b32 v171, 0xffff0000, v133
    v_lshlrev_b32 v172, 16, v134
    v_and_b32 v173, 0xffff0000, v134
    v_lshlrev_b32 v174, 16, v135
    v_and_b32 v175, 0xffff0000, v135
    v_pk_fma_f32 v[160:161], s[78:79], v[168:169], v[160:161] op_sel:[1,0,0] op_sel_hi:[1,1,1]
    v_pk_fma_f32 v[162:163], s[78:79], v[170:171], v[162:163] op_sel:[1,0,0] op_sel_hi:[1,1,1]
    v_pk_fma_f32 v[164:165], s[78:79], v[172:173], v[164:165] op_sel:[1,0,0] op_sel_hi:[1,1,1]
    v_pk_fma_f32 v[166:167], s[78:79], v[174:175], v[166:167] op_sel:[1,0,0] op_sel_hi:[1,1,1]
    v_lshlrev_b32 v144, 11, v4
    v_lshl_add_u32 v144, v1, 5, v144
    ds_write_b128 v144, v[160:163] offset:16384
    ds_write_b128 v144, v[164:167] offset:16400
    s_waitcnt lgkmcnt(0)
    s_barrier
    v_lshlrev_b32 v144, 3, v0
    ds_read_b64 v[192:193], v144 offset:16384
    ds_read_b64 v[194:195], v144 offset:18432
    ds_read_b64 v[196:197], v144 offset:20480
    ds_read_b64 v[198:199], v144 offset:22528
    s_lshl_b32 s69, s2, 12
    s_add_u32 s69, s69, 1327104
    s_waitcnt lgkmcnt(0)
    v_pk_add_f32 v[192:193], v[192:193], v[194:195]
    v_pk_add_f32 v[192:193], v[192:193], v[196:197]
    v_pk_add_f32 v[192:193], v[192:193], v[198:199]
    v_mov_b32 v194, v193
    v_mov_b32 v193, s97
    v_mov_b32 v195, s97
    buffer_store_dwordx4 v[192:195], v145, s[40:43], s69 offen sc1
    s_branch END
ROLED:
    s_sub_u32 s68, s2, 28
    v_lshlrev_b32 v148, 1, v1
    s_lshl_b32 s69, s68, 7
    buffer_load_ushort v141, v148, s[52:55], s69 offen
    buffer_load_ushort v140, v148, s[12:15], s69 offen
    v_lshlrev_b32 v144, 3, v1
    s_lshl_b32 s70, s68, 9
    s_lshl_b32 s72, s60, 15
    s_add_u32 s72, s72, s70
    s_add_u32 s72, s72, 1196032
    v_add_u32 v145, 4096, v144
    v_add_u32 v146, 8192, v144
    v_add_u32 v147, 12288, v144
    s_add_u32 s73, s72, 16384
    buffer_load_dwordx2 v[8:9], v144, s[40:43], s72 offen sc1
    buffer_load_dwordx2 v[10:11], v145, s[40:43], s72 offen sc1
    buffer_load_dwordx2 v[12:13], v146, s[40:43], s72 offen sc1
    buffer_load_dwordx2 v[14:15], v147, s[40:43], s72 offen sc1
    buffer_load_dwordx2 v[16:17], v144, s[40:43], s73 offen sc1
    buffer_load_dwordx2 v[18:19], v145, s[40:43], s73 offen sc1
    buffer_load_dwordx2 v[20:21], v146, s[40:43], s73 offen sc1
    buffer_load_dwordx2 v[22:23], v147, s[40:43], s73 offen sc1
    s_mov_b32 s71, 0
PP5:
    s_waitcnt vmcnt(0)
    v_xor_b32 v250, s97, v9
    v_xor_b32 v251, s97, v11
    v_or_b32 v250, v250, v251
    v_xor_b32 v251, s97, v13
    v_or_b32 v250, v250, v251
    v_xor_b32 v251, s97, v15
    v_or_b32 v250, v250, v251
    v_xor_b32 v251, s97, v17
    v_or_b32 v250, v250, v251
    v_xor_b32 v251, s97, v19
    v_or_b32 v250, v250, v251
    v_xor_b32 v251, s97, v21
    v_or_b32 v250, v250, v251
    v_xor_b32 v251, s97, v23
    v_or_b32 v250, v250, v251
    v_cmp_eq_u32 vcc, 0, v250
    s_nop 4
    s_cmp_eq_u64 vcc, exec
    s_cbranch_scc1 PD5_0
    buffer_load_dwordx2 v[8:9], v144, s[40:43], s72 offen sc1
    buffer_load_dwordx2 v[10:11], v145, s[40:43], s72 offen sc1
    buffer_load_dwordx2 v[12:13], v146, s[40:43], s72 offen sc1
    buffer_load_dwordx2 v[14:15], v147, s[40:43], s72 offen sc1
    buffer_load_dwordx2 v[16:17], v144, s[40:43], s73 offen sc1
    buffer_load_dwordx2 v[18:19], v145, s[40:43], s73 offen sc1
    buffer_load_dwordx2 v[20:21], v146, s[40:43], s73 offen sc1
    buffer_load_dwordx2 v[22:23], v147, s[40:43], s73 offen sc1
    s_sleep 1
    s_add_u32 s71, s71, 1
    s_cmp_lt_u32 s71, 0x8000
    s_cbranch_scc1 PP5
PD5_0:
    v_add_f32 v150, v8, v10
    v_add_f32 v150, v150, v12
    v_add_f32 v150, v150, v14
    v_add_f32 v150, v150, v16
    v_add_f32 v150, v150, v18
    v_add_f32 v150, v150, v20
    v_add_f32 v150, v150, v22
PE5:
    s_mul_i32 s72, s60, 28672
    s_add_u32 s72, s72, s70
    s_add_u32 s72, s72, 1327104
    s_add_u32 s73, s72, 16384
    buffer_load_dwordx2 v[152:153], v144, s[40:43], s72 offen sc1
    buffer_load_dwordx2 v[154:155], v145, s[40:43], s72 offen sc1
    buffer_load_dwordx2 v[156:157], v146, s[40:43], s72 offen sc1
    buffer_load_dwordx2 v[158:159], v147, s[40:43], s72 offen sc1
    buffer_load_dwordx2 v[160:161], v144, s[40:43], s73 offen sc1
    buffer_load_dwordx2 v[162:163], v145, s[40:43], s73 offen sc1
    buffer_load_dwordx2 v[164:165], v146, s[40:43], s73 offen sc1
    s_mov_b32 s71, 0
PP6:
    s_waitcnt vmcnt(0)
    v_xor_b32 v250, s97, v153
    v_xor_b32 v251, s97, v155
    v_or_b32 v250, v250, v251
    v_xor_b32 v251, s97, v157
    v_or_b32 v250, v250, v251
    v_xor_b32 v251, s97, v159
    v_or_b32 v250, v250, v251
    v_xor_b32 v251, s97, v161
    v_or_b32 v250, v250, v251
    v_xor_b32 v251, s97, v163
    v_or_b32 v250, v250, v251
    v_xor_b32 v251, s97, v165
    v_or_b32 v250, v250, v251
    v_cmp_eq_u32 vcc, 0, v250
    s_nop 4
    s_cmp_eq_u64 vcc, exec
    s_cbranch_scc1 PD6_0
    buffer_load_dwordx2 v[152:153], v144, s[40:43], s72 offen sc1
    buffer_load_dwordx2 v[154:155], v145, s[40:43], s72 offen sc1
    buffer_load_dwordx2 v[156:157], v146, s[40:43], s72 offen sc1
    buffer_load_dwordx2 v[158:159], v147, s[40:43], s72 offen sc1
    buffer_load_dwordx2 v[160:161], v144, s[40:43], s73 offen sc1
    buffer_load_dwordx2 v[162:163], v145, s[40:43], s73 offen sc1
    buffer_load_dwordx2 v[164:165], v146, s[40:43], s73 offen sc1
    s_sleep 1
    s_add_u32 s71, s71, 1
    s_cmp_lt_u32 s71, 0x8000
    s_cbranch_scc1 PP6
PD6_0:
    v_add_f32 v151, v152, v154
    v_add_f32 v151, v151, v156
    v_add_f32 v151, v151, v158
    v_add_f32 v151, v151, v160
    v_add_f32 v151, v151, v162
    v_add_f32 v151, v151, v164
PE6:
    v_lshlrev_b32 v144, 9, v4
    v_lshl_add_u32 v144, v1, 3, v144
    ds_write_b64 v144, v[150:151] offset:0
    s_waitcnt lgkmcnt(0)
    s_barrier
    s_cmp_lg_u32 s60, 0
    s_cbranch_scc1 END
    v_lshlrev_b32 v144, 3, v1
    ds_read_b64 v[104:105], v144 offset:0
    ds_read_b64 v[106:107], v144 offset:512
    ds_read_b64 v[108:109], v144 offset:1024
    ds_read_b64 v[110:111], v144 offset:1536
    s_waitcnt lgkmcnt(0)
    v_pk_add_f32 v[104:105], v[104:105], v[106:107]
    v_pk_add_f32 v[104:105], v[104:105], v[108:109]
    v_pk_add_f32 v[104:105], v[104:105], v[110:111]
    v_cvt_pk_bf16_f32 v104, v104, v104
    v_lshlrev_b32 v104, 16, v104
    v_lshlrev_b32 v140, 16, v140
    v_add_f32 v104, v104, v140
    v_cvt_pk_bf16_f32 v104, v104, v104
    v_lshlrev_b32 v104, 16, v104
    v_cvt_pk_bf16_f32 v105, v105, v105
    v_lshlrev_b32 v105, 16, v105
    v_lshlrev_b32 v141, 16, v141
    v_add_f32 v105, v105, v141
    v_cvt_pk_bf16_f32 v105, v105, v105
    v_lshlrev_b32 v105, 16, v105
    v_add_f32 v105, v105, v104
    v_cvt_pk_bf16_f32 v105, v105, v105
    s_lshl_b32 s69, s68, 7
    buffer_store_short v105, v148, s[56:59], s69 offen
    s_branch END
MW:
    v_mov_b32 v144, 3076
    v_mov_b32 v145, 0
    ds_write_b32 v144, v145
    s_waitcnt lgkmcnt(0)
    s_barrier
    s_cmp_lg_u32 s2, 0
    s_cbranch_scc1 NONW
    s_memrealtime s[94:95]
    s_waitcnt lgkmcnt(0)
    s_or_b32 s94, s94, 1
    v_mov_b32 v250, 0
    v_mov_b32 v251, s94
    buffer_store_dword v251, v250, s[44:47], 0 offen sc1
NONW:
    v_mov_b32 v252, 0
    buffer_load_dword v230, v252, s[44:47], 0 offen sc1
    s_mov_b32 s71, 0
NL:
    s_waitcnt vmcnt(0)
    v_readfirstlane_b32 s97, v230
    s_nop 3
    s_cmp_lg_u32 s97, 0
    s_cbranch_scc1 ND
    buffer_load_dword v230, v252, s[44:47], 0 offen sc1
    s_sleep 1
    s_add_u32 s71, s71, 1
    s_cmp_lt_u32 s71, 0x8000
    s_cbranch_scc1 NL
ND:
    v_mov_b32 v144, 3072
    v_mov_b32 v145, s97
    ds_write_b32 v144, v145
    v_lshlrev_b32 v144, 2, v1
    s_and_b32 s69, s2, 3
    s_lshl_b32 s69, s69, 15
    s_lshr_b32 s74, s2, 2
    s_lshl_b32 s74, s74, 9
    s_add_u32 s69, s69, s74
    v_lshlrev_b32 v146, 3, v1
    v_lshlrev_b32 v147, 4, v1
    v_mov_b32 v148, 3076
    s_mov_b32 s71, 0
CL:
    ds_read_b32 v149, v148
    s_waitcnt lgkmcnt(0)
    v_readfirstlane_b32 s72, v149
    s_nop 3
    s_cmp_eq_u32 s72, 256
    s_cbranch_scc1 CD
    s_add_u32 s71, s71, 1
    s_cmp_lt_u32 s71, 0x100000
    s_cbranch_scc1 CL
CD:
    ds_read_b32 v160, v144 offset:8192
    ds_read_b32 v161, v144 offset:8448
    ds_read_b32 v162, v144 offset:8704
    ds_read_b32 v163, v144 offset:8960
    ds_read_b32 v164, v144 offset:9216
    ds_read_b32 v165, v144 offset:9472
    ds_read_b32 v166, v144 offset:9728
    ds_read_b32 v167, v144 offset:9984
    ds_read_b32 v168, v144 offset:10240
    ds_read_b32 v169, v144 offset:10496
    ds_read_b32 v170, v144 offset:10752
    ds_read_b32 v171, v144 offset:11008
    ds_read_b32 v172, v144 offset:11264
    ds_read_b32 v173, v144 offset:11520
    ds_read_b32 v174, v144 offset:11776
    ds_read_b32 v175, v144 offset:12032
    ds_read_b32 v176, v144 offset:12288
    ds_read_b32 v177, v144 offset:12544
    ds_read_b32 v178, v144 offset:12800
    ds_read_b32 v179, v144 offset:13056
    ds_read_b32 v180, v144 offset:13312
    ds_read_b32 v181, v144 offset:13568
    ds_read_b32 v182, v144 offset:13824
    ds_read_b32 v183, v144 offset:14080
    ds_read_b32 v184, v144 offset:14336
    ds_read_b32 v185, v144 offset:14592
    ds_read_b32 v186, v144 offset:14848
    ds_read_b32 v187, v144 offset:15104
    ds_read_b32 v188, v144 offset:15360
    ds_read_b32 v189, v144 offset:15616
    ds_read_b32 v190, v144 offset:15872
    ds_read_b32 v191, v144 offset:16128
    s_waitcnt lgkmcnt(0)
    v_add_f32 v160, v160, v161
    v_add_f32 v160, v160, v162
    v_add_f32 v160, v160, v163
    v_add_f32 v160, v160, v164
    v_add_f32 v160, v160, v165
    v_add_f32 v160, v160, v166
    v_add_f32 v160, v160, v167
    v_add_f32 v160, v160, v168
    v_add_f32 v160, v160, v169
    v_add_f32 v160, v160, v170
    v_add_f32 v160, v160, v171
    v_add_f32 v160, v160, v172
    v_add_f32 v160, v160, v173
    v_add_f32 v160, v160, v174
    v_add_f32 v160, v160, v175
    v_add_f32 v160, v160, v176
    v_add_f32 v160, v160, v177
    v_add_f32 v160, v160, v178
    v_add_f32 v160, v160, v179
    v_add_f32 v160, v160, v180
    v_add_f32 v160, v160, v181
    v_add_f32 v160, v160, v182
    v_add_f32 v160, v160, v183
    v_add_f32 v160, v160, v184
    v_add_f32 v160, v160, v185
    v_add_f32 v160, v160, v186
    v_add_f32 v160, v160, v187
    v_add_f32 v160, v160, v188
    v_add_f32 v160, v160, v189
    v_add_f32 v160, v160, v190
    v_add_f32 v160, v160, v191
    v_mov_b32 v161, s97
    buffer_store_dwordx2 v[160:161], v146, s[40:43], s69 offen sc1
    s_lshl_b32 s69, s61, 12
    v_and_b32 v148, 3, v1
    v_lshlrev_b32 v148, 15, v148
    v_bfe_u32 v149, v1, 2, 3
    v_lshl_add_u32 v148, v149, 9, v148
    buffer_load_dwordx2 v[228:229], v148, s[40:43], s69 offen sc1
    s_mov_b32 s71, 0
PP7:
    s_waitcnt vmcnt(0)
    v_xor_b32 v250, s97, v229
    v_cmp_eq_u32 vcc, 0, v250
    s_nop 4
    s_cmp_eq_u64 vcc, exec
    s_cbranch_scc1 PD7_0
    buffer_load_dwordx2 v[228:229], v148, s[40:43], s69 offen sc1
    s_sleep 1
    s_add_u32 s71, s71, 1
    s_cmp_lt_u32 s71, 0x8000
    s_cbranch_scc1 PP7
PD7_0:
PE7:
    s_mov_b32 s71, 0
GL8:
    s_add_u32 s70, s69, 0
    buffer_load_dwordx4 v[160:163], v147, s[40:43], s70 offen offset:0 sc1
    buffer_load_dwordx4 v[164:167], v147, s[40:43], s70 offen offset:1024 sc1
    buffer_load_dwordx4 v[168:171], v147, s[40:43], s70 offen offset:2048 sc1
    buffer_load_dwordx4 v[172:175], v147, s[40:43], s70 offen offset:3072 sc1
    s_add_u32 s70, s69, 32768
    buffer_load_dwordx4 v[176:179], v147, s[40:43], s70 offen offset:0 sc1
    buffer_load_dwordx4 v[180:183], v147, s[40:43], s70 offen offset:1024 sc1
    buffer_load_dwordx4 v[184:187], v147, s[40:43], s70 offen offset:2048 sc1
    buffer_load_dwordx4 v[188:191], v147, s[40:43], s70 offen offset:3072 sc1
    s_add_u32 s70, s69, 65536
    buffer_load_dwordx4 v[192:195], v147, s[40:43], s70 offen offset:0 sc1
    buffer_load_dwordx4 v[196:199], v147, s[40:43], s70 offen offset:1024 sc1
    buffer_load_dwordx4 v[200:203], v147, s[40:43], s70 offen offset:2048 sc1
    buffer_load_dwordx4 v[204:207], v147, s[40:43], s70 offen offset:3072 sc1
    s_add_u32 s70, s69, 98304
    buffer_load_dwordx4 v[208:211], v147, s[40:43], s70 offen offset:0 sc1
    buffer_load_dwordx4 v[212:215], v147, s[40:43], s70 offen offset:1024 sc1
    buffer_load_dwordx4 v[216:219], v147, s[40:43], s70 offen offset:2048 sc1
    buffer_load_dwordx4 v[220:223], v147, s[40:43], s70 offen offset:3072 sc1
    s_waitcnt vmcnt(0)
    v_xor_b32 v250, s97, v161
    v_xor_b32 v251, s97, v163
    v_or_b32 v250, v250, v251
    v_xor_b32 v251, s97, v165
    v_or_b32 v250, v250, v251
    v_xor_b32 v251, s97, v167
    v_or_b32 v250, v250, v251
    v_xor_b32 v251, s97, v169
    v_or_b32 v250, v250, v251
    v_xor_b32 v251, s97, v171
    v_or_b32 v250, v250, v251
    v_xor_b32 v251, s97, v173
    v_or_b32 v250, v250, v251
    v_xor_b32 v251, s97, v175
    v_or_b32 v250, v250, v251
    v_xor_b32 v251, s97, v177
    v_or_b32 v250, v250, v251
    v_xor_b32 v251, s97, v179
    v_or_b32 v250, v250, v251
    v_xor_b32 v251, s97, v181
    v_or_b32 v250, v250, v251
    v_xor_b32 v251, s97, v183
    v_or_b32 v250, v250, v251
    v_xor_b32 v251, s97, v185
    v_or_b32 v250, v250, v251
    v_xor_b32 v251, s97, v187
    v_or_b32 v250, v250, v251
    v_xor_b32 v251, s97, v189
    v_or_b32 v250, v250, v251
    v_xor_b32 v251, s97, v191
    v_or_b32 v250, v250, v251
    v_xor_b32 v251, s97, v193
    v_or_b32 v250, v250, v251
    v_xor_b32 v251, s97, v195
    v_or_b32 v250, v250, v251
    v_xor_b32 v251, s97, v197
    v_or_b32 v250, v250, v251
    v_xor_b32 v251, s97, v199
    v_or_b32 v250, v250, v251
    v_xor_b32 v251, s97, v201
    v_or_b32 v250, v250, v251
    v_xor_b32 v251, s97, v203
    v_or_b32 v250, v250, v251
    v_xor_b32 v251, s97, v205
    v_or_b32 v250, v250, v251
    v_xor_b32 v251, s97, v207
    v_or_b32 v250, v250, v251
    v_xor_b32 v251, s97, v209
    v_or_b32 v250, v250, v251
    v_xor_b32 v251, s97, v211
    v_or_b32 v250, v250, v251
    v_xor_b32 v251, s97, v213
    v_or_b32 v250, v250, v251
    v_xor_b32 v251, s97, v215
    v_or_b32 v250, v250, v251
    v_xor_b32 v251, s97, v217
    v_or_b32 v250, v250, v251
    v_xor_b32 v251, s97, v219
    v_or_b32 v250, v250, v251
    v_xor_b32 v251, s97, v221
    v_or_b32 v250, v250, v251
    v_xor_b32 v251, s97, v223
    v_or_b32 v250, v250, v251
    v_cmp_eq_u32 vcc, 0, v250
    s_nop 4
    s_cmp_eq_u64 vcc, exec
    s_cbranch_scc1 GD8
    s_add_u32 s71, s71, 1
    s_cmp_lt_u32 s71, 0x20000
    s_cbranch_scc1 GL8
GD8:
    v_add_f32 v160, v160, v176
    v_add_f32 v162, v162, v178
    v_add_f32 v160, v160, v192
    v_add_f32 v162, v162, v194
    v_add_f32 v160, v160, v208
    v_add_f32 v162, v162, v210
    v_cvt_pk_bf16_f32 v160, v160, v162
    ds_write_b32 v144, v160 offset:2048
    v_add_f32 v164, v164, v180
    v_add_f32 v166, v166, v182
    v_add_f32 v164, v164, v196
    v_add_f32 v166, v166, v198
    v_add_f32 v164, v164, v212
    v_add_f32 v166, v166, v214
    v_cvt_pk_bf16_f32 v164, v164, v166
    ds_write_b32 v144, v164 offset:2304
    v_add_f32 v168, v168, v184
    v_add_f32 v170, v170, v186
    v_add_f32 v168, v168, v200
    v_add_f32 v170, v170, v202
    v_add_f32 v168, v168, v216
    v_add_f32 v170, v170, v218
    v_cvt_pk_bf16_f32 v168, v168, v170
    ds_write_b32 v144, v168 offset:2560
    v_add_f32 v172, v172, v188
    v_add_f32 v174, v174, v190
    v_add_f32 v172, v172, v204
    v_add_f32 v174, v174, v206
    v_add_f32 v172, v172, v220
    v_add_f32 v174, v174, v222
    v_cvt_pk_bf16_f32 v172, v172, v174
    ds_write_b32 v144, v172 offset:2816
    s_waitcnt lgkmcnt(0)
    s_barrier
END:
    s_endpgm
.section .rodata,"a"
.p2align 6
.amdhsa_kernel sequential_preLN__sliding_block_cached__dense_activation_gelu__decode_kernel
  .amdhsa_next_free_vgpr 256
  .amdhsa_next_free_sgpr 102
  .amdhsa_accum_offset 256
  .amdhsa_group_segment_fixed_size 0
  .amdhsa_kernarg_size 104
  .amdhsa_user_sgpr_count 2
  .amdhsa_user_sgpr_kernarg_segment_ptr 1
  .amdhsa_system_sgpr_workgroup_id_x 1
.end_amdhsa_kernel
```
